```python
import torch

def _softmax(x, axis=-1):
    return torch.softmax(x, dim=axis)
def _gelu(x):
    return torch.nn.functional.gelu(x, approximate="tanh")
def _silu(x):
    return torch.nn.functional.silu(x)
def _sigmoid(x):
    return torch.sigmoid(x)
def _layernorm(x, axis=-1, eps=1e-5):
    m = x.mean(dim=axis, keepdim=True)
    v = x.var(dim=axis, keepdim=True, unbiased=False)
    return (x - m) / torch.sqrt(v + eps)
def _scatter_add(tgt, idx, src, axis=0):
    return tgt.clone().index_add_(axis, idx, src)
def _segment_sum(src, seg, n):
    out = torch.zeros((n,) + src.shape[1:], dtype=src.dtype)
    return out.index_add_(0, seg, src)
def _pad(x, pw):
    flat = tuple(v for pair in reversed(pw) for v in pair)
    return torch.nn.functional.pad(x, flat)

kernel_name = 'sequential_preLN__spectral_gfnet__moe_arch_mod__prompt'

def setup_inputs():

    _w = (lambda a: (lambda t: t.to(torch.bfloat16) if t.is_floating_point() else t)(torch.as_tensor(a)))
    def _A_setup():
        B, S, D = 1, 2048, 1024
        Df = D // 2 + 1
        return {
            "x": _w((lambda *s: torch.randn(*s, dtype=torch.bfloat16) * 0.05)(B, S, D)),
            "w_r": _w((lambda *s: torch.randn(*s, dtype=torch.bfloat16) * 1.6)(S, Df) * 0.02),
            "w_i": _w((lambda *s: torch.randn(*s, dtype=torch.bfloat16) * 1.6)(S, Df) * 0.02),
        }
    _A_in = _A_setup()

    def _B_setup():
        B, S, D, F, C = 1, 2048, 1024, 3584, 8
        return {
            "x": _w((lambda *s: torch.randn(*s, dtype=torch.bfloat16) * 0.05)(B, S, D)),
            "w_r": _w((lambda *s: torch.randn(*s, dtype=torch.bfloat16) * 0.2)(D)),
            "w_gate": _w((lambda *s: torch.randn(*s, dtype=torch.bfloat16) * 0.2)(D, F)),
            "w_up": _w((lambda *s: torch.randn(*s, dtype=torch.bfloat16) * 0.2)(D, F)),
            "w_down": _w((lambda *s: torch.randn(*s, dtype=torch.bfloat16) * 0.2)(F, D)),
        }
    _B_in = _B_setup()

    return {
        "A_x": _A_in["x"],
        "A_w_r": _A_in["w_r"],
        "A_w_i": _A_in["w_i"],
        "B_x": _B_in["x"],
        "B_w_r": _B_in["w_r"],
        "B_w_gate": _B_in["w_gate"],
        "B_w_up": _B_in["w_up"],
        "B_w_down": _B_in["w_down"],
    }

def reference(A_x, A_w_r, A_w_i, B_x, B_w_r, B_w_gate, B_w_up, B_w_down):
    def _A_ref(x, w_r, w_i):
        B, S, D = x.shape
        X = (lambda x, axes=(-2,-1): torch.fft.rfft2(x.float(), dim=axes))(x, axes=(-2, -1))
        W = w_r + 1j * w_i
        X = X * W
        y = (lambda x, s, axes=(-2,-1): torch.fft.irfft2(x, s=s, dim=axes).to(torch.bfloat16))(X, (S, D), axes=(-2, -1))
        return y

    def _B_ref(x, w_r, w_gate, w_up, w_down):
        B, S, D = x.shape
        C = 8
        r = x @ w_r
        idx = torch.argsort(-r, axis=-1)[:, :C]
        idx_e = (lambda x, n, axis: torch.repeat_interleave(x, n, dim=axis))(idx.reshape(B, C, 1), D, axis=2)
        x_sel = (lambda x, i, axis: torch.take_along_dim(x, i, dim=axis))(x, idx_e, axis=1)
        g = _silu(x_sel @ w_gate)
        u = x_sel @ w_up
        y = (g * u) @ w_down
        r_sel = _sigmoid((lambda x, i, axis: torch.take_along_dim(x, i, dim=axis))(r, idx, axis=1))
        y = y * r_sel.reshape(B, C, 1)
        b_off = (torch.arange(B) * S).reshape(B, 1)
        flat_idx = (idx + b_off).reshape(B * C)
        zero = (x * 0.0).reshape(B * S, D)
        upd = _scatter_add(zero, flat_idx, y.reshape(B * C, D), axis=0)
        return x + upd.reshape(B, S, D)

    x = A_x
    h = x + _A_ref(_layernorm(x, axis=-1), A_w_r, A_w_i)
    h2 = h + _B_ref(_layernorm(h, axis=-1), B_w_r, B_w_gate, B_w_up, B_w_down)
    return h2
```

```asm
; @launch kernel=sequential_preLN__spectral_gfnet__moe_arch_mod__prompt_kernel grid=(256,1,1) block=(768,1,1) lds=154368
.amdgcn_target "amdgcn-amd-amdhsa--gfx950"
.text
.globl sequential_preLN__spectral_gfnet__moe_arch_mod__prompt_kernel
.p2align 8
.type sequential_preLN__spectral_gfnet__moe_arch_mod__prompt_kernel,@function
sequential_preLN__spectral_gfnet__moe_arch_mod__prompt_kernel:
    s_cmp_ge_u32 s2, 256
    s_cbranch_scc1 m_end
    s_load_dwordx4 s[4:7], s[0:1], 0
    s_memrealtime s[92:93]
    s_load_dwordx2 s[8:9], s[0:1], 16
    s_load_dwordx2 s[10:11], s[0:1], 80
    s_load_dwordx8 s[64:71], s[0:1], 32
    s_load_dwordx4 s[72:75], s[0:1], 64
    s_getpc_b64 s[28:29]
m_pc0:
    v_lshlrev_b32 v162, 7, v0
    v_cmp_gt_u32 vcc, m_end-m_pc0, v162
    s_nop 0
    s_and_saveexec_b64 s[30:31], vcc
    s_cbranch_execz m_pc1
    global_load_dword v163, v162, s[28:29]
m_pc1:
    s_mov_b64 exec, s[30:31]
m_pc2:
    v_lshrrev_b32 v7, 6, v0
    v_and_b32 v1, 63, v0
    v_readfirstlane_b32 s94, v7
    v_lshlrev_b32 v5, 4, v1
    v_lshlrev_b32 v4, 2, v1
    s_cmp_ge_u32 s94, 8
    s_cbranch_scc1 m_helper
    s_and_b32 s30, s2, 0xf0
    s_and_b32 s31, s2, 7
    s_lshl_b32 s31, s31, 1
    s_or_b32 s30, s30, s31
    s_bfe_u32 s31, s2, 0x10003
    s_or_b32 s30, s30, s31
    s_lshl_b32 s45, s94, 8
    s_add_u32 s45, s45, s30
    s_lshl_b32 s31, s45, 11
    v_add_u32 v8, s31, v4
    s_getpc_b64 s[28:29]
    s_add_u32 s28, s28, tab1@rel32@lo+4
    s_addc_u32 s29, s29, tab1@rel32@hi+12
    s_lshl_b32 s3, s94, 11
    s_add_u32 s28, s28, s3
    s_addc_u32 s29, s29, 0
    s_mov_b32 m0, s3
    s_nop 0
    global_load_lds_dwordx4 v5, s[28:29]
    global_load_lds_dwordx4 v5, s[28:29] offset:1024
    s_waitcnt lgkmcnt(0)
    global_load_dword v128, v8, s[4:5] offset:0 nt
    global_load_dword v129, v8, s[4:5] offset:256 nt
    global_load_dword v130, v8, s[4:5] offset:512 nt
    global_load_dword v131, v8, s[4:5] offset:768 nt
    global_load_dword v132, v8, s[4:5] offset:1024 nt
    global_load_dword v133, v8, s[4:5] offset:1280 nt
    global_load_dword v134, v8, s[4:5] offset:1536 nt
    global_load_dword v135, v8, s[4:5] offset:1792 nt
    s_branch m_comp
m_helper:
    s_setprio 3
    s_sub_u32 s59, s94, 8
    s_and_b32 s33, s2, 0xf8
    s_lshl_b32 s34, s59, 1
    s_add_u32 s33, s33, s34
    s_lshl_b32 s33, s33, 2
    s_and_b32 s34, s2, 3
    s_add_u32 s33, s33, s34
    s_mul_i32 s33, s33, 2052
    s_and_b32 s34, s2, 4
    s_lshl_b32 s34, s34, 7
    s_add_u32 s33, s33, s34
    v_lshl_add_u32 v22, v1, 3, s33
    v_add_u32 v23, 8208, v22
    s_waitcnt lgkmcnt(0)
    s_or_b32 s60, s2, s59
    s_cmp_lg_u32 s60, 0
    s_cbranch_scc1 m_nn
    s_lshl_b64 s[92:93], s[92:93], 8
    s_or_b32 s93, s93, 0x80000000
    v_mov_b32 v16, s92
    v_mov_b32 v17, s93
    v_mov_b32 v18, 0
    s_mov_b64 exec, 1
    global_store_dwordx2 v18, v[16:17], s[74:75] sc1
    s_mov_b64 exec, -1
m_nn:
    s_barrier
    global_load_dwordx2 v[32:33], v22, s[6:7] offset:2
    global_load_dwordx2 v[34:35], v22, s[8:9] offset:2
    global_load_dwordx2 v[36:37], v22, s[6:7] offset:1028
    global_load_dwordx2 v[38:39], v22, s[8:9] offset:1028
    global_load_dwordx2 v[40:41], v23, s[6:7] offset:2
    global_load_dwordx2 v[42:43], v23, s[8:9] offset:2
    global_load_dwordx2 v[44:45], v23, s[6:7] offset:1028
    global_load_dwordx2 v[46:47], v23, s[8:9] offset:1028
    s_branch m_helper2
m_comp:
    v_and_b32 v2, 15, v1
    v_lshrrev_b32 v3, 4, v1
    v_mov_b32 v164, 148480
    v_mov_b32 v165, 1
    s_mov_b32 s26, 0x1400000
    s_mov_b32 s27, 0x00020000
    s_mov_b32 s58, 0
    s_and_b32 s50, s2, 7
    s_mul_i32 s50, s50, 7
    s_lshr_b32 s51, s2, 5
    s_add_u32 s54, s51, 3
    s_cmp_ge_u32 s54, 7
    s_cselect_b32 s55, 7, 0
    s_sub_u32 s54, s54, s55
    s_add_u32 s54, s54, s50
    s_add_u32 s50, s50, s51
    s_bfe_u32 s51, s2, 0x20003
    s_mov_b32 s55, s51
    v_mov_b32 v9, 0
    v_add_u32 v10, v164, v4
    s_mov_b64 exec, 0xffffff
    ds_write_b32 v10, v9 offset:32
    s_mov_b64 exec, -1
    v_lshrrev_b32 v32, 1, v2
    v_and_b32 v33, 1, v2
    v_cvt_f32_u32 v33, v33
    v_mul_f32 v33, 0.5, v33
    v_mul_f32 v33, 0.5, v33
    v_lshlrev_b32 v34, 9, v3
    v_add_u32 v34, s30, v34
    v_mul_u32_u24 v34, v34, v32
    v_and_b32 v34, 0x7ff, v34
    v_cvt_f32_u32 v34, v34
    v_mul_f32 v34, 0x3a000000, v34
    v_add_f32 v34, v34, v33
    v_cos_f32 v35, v34
    v_sin_f32 v34, v34
    s_nop 0
    v_cvt_pk_f16_f32 v144, v35, v34
    v_lshlrev_b32 v34, 9, v3
    v_add_u32 v34, s30, v34
    v_add_u32 v34, 0x100, v34
    v_mul_u32_u24 v34, v34, v32
    v_and_b32 v34, 0x7ff, v34
    v_cvt_f32_u32 v34, v34
    v_mul_f32 v34, 0x3a000000, v34
    v_add_f32 v34, v34, v33
    v_cos_f32 v35, v34
    v_sin_f32 v34, v34
    s_nop 0
    v_cvt_pk_f16_f32 v145, v35, v34
    s_mov_b32 s24, s10
    s_mov_b32 s25, s11
    s_mov_b32 s16, s64
    s_mov_b32 s17, s65
    s_mov_b32 s18, 0x800
    s_mov_b32 s19, 0x00020000
    s_mov_b32 s20, s72
    s_mov_b32 s21, s73
    s_mov_b32 s22, 0x400000
    s_mov_b32 s23, 0x00020000
    s_lshr_b32 s34, s94, 1
    s_mul_i32 s34, s34, 4224
    s_and_b32 s35, s94, 1
    s_lshl_b32 s35, s35, 2
    s_add_u32 s34, s34, s35
    s_add_u32 s34, s34, 16896
    v_lshlrev_b32 v146, 10, v3
    v_lshl_add_u32 v146, v2, 3, v146
    v_add_u32 v146, s34, v146
    v_lshlrev_b32 v166, 3, v2
    v_add_u32 v166, s34, v166
    s_sub_u32 s56, s34, 12800
    v_mul_u32_u24 v147, 4224, v3
    v_lshl_add_u32 v147, v2, 3, v147
    s_lshl_b32 s35, s94, 9
    v_add_u32 v147, s35, v147
    v_mul_u32_u24 v6, 1048576, v3
    v_mov_b32 v167, v6
    v_lshl_add_u32 v6, v2, 3, v6
    v_lshl_add_u32 v167, v2, 2, v167
    s_mul_i32 s33, s94, 65536
    s_lshl_b32 s41, s30, 6
    s_add_u32 s40, s33, s41
    s_and_b32 s41, s41, 0xffffff80
    s_add_u32 s33, s33, s41
    s_and_b32 s41, s30, 1
    s_lshl_b32 s41, s41, 2
    s_add_u32 s33, s33, s41
    s_mov_b64 s[46:47], 1
    s_waitcnt vmcnt(8) lgkmcnt(0)
    s_barrier
    ds_read_b128 v[64:67], v5 offset:0
    ds_read_b128 v[68:71], v5 offset:1024
    ds_read_b128 v[72:75], v5 offset:2048
    ds_read_b128 v[76:79], v5 offset:3072
    ds_read_b128 v[80:83], v5 offset:4096
    ds_read_b128 v[84:87], v5 offset:5120
    ds_read_b128 v[88:91], v5 offset:6144
    ds_read_b128 v[92:95], v5 offset:7168
    ds_read_b128 v[96:99], v5 offset:8192
    ds_read_b128 v[100:103], v5 offset:9216
    ds_read_b128 v[104:107], v5 offset:10240
    ds_read_b128 v[108:111], v5 offset:11264
    ds_read_b128 v[112:115], v5 offset:12288
    ds_read_b128 v[116:119], v5 offset:13312
    ds_read_b128 v[120:123], v5 offset:14336
    ds_read_b128 v[124:127], v5 offset:15360
    s_setprio 2
    s_mov_b32 s62, 0x3727c5ac
    s_mov_b32 s101, 0
    s_waitcnt vmcnt(0)
m_row1:
    v_lshlrev_b32 v16, 16, v128
    v_and_b32 v24, 0xffff0000, v128
    v_readfirstlane_b32 s36, v16
    v_lshlrev_b32 v17, 16, v129
    v_and_b32 v25, 0xffff0000, v129
    v_lshlrev_b32 v18, 16, v130
    v_and_b32 v26, 0xffff0000, v130
    v_lshlrev_b32 v19, 16, v131
    v_and_b32 v27, 0xffff0000, v131
    v_lshlrev_b32 v20, 16, v132
    v_and_b32 v28, 0xffff0000, v132
    v_lshlrev_b32 v21, 16, v133
    v_and_b32 v29, 0xffff0000, v133
    v_lshlrev_b32 v22, 16, v134
    v_and_b32 v30, 0xffff0000, v134
    v_lshlrev_b32 v23, 16, v135
    v_and_b32 v31, 0xffff0000, v135
    v_subrev_f32 v16, s36, v16
    v_subrev_f32 v17, s36, v17
    v_subrev_f32 v18, s36, v18
    v_subrev_f32 v19, s36, v19
    v_subrev_f32 v20, s36, v20
    v_subrev_f32 v21, s36, v21
    v_subrev_f32 v22, s36, v22
    v_subrev_f32 v23, s36, v23
    v_subrev_f32 v24, s36, v24
    v_subrev_f32 v25, s36, v25
    v_subrev_f32 v26, s36, v26
    v_subrev_f32 v27, s36, v27
    v_subrev_f32 v28, s36, v28
    v_subrev_f32 v29, s36, v29
    v_subrev_f32 v30, s36, v30
    v_subrev_f32 v31, s36, v31
    v_add_f32 v32, v16, v17
    v_add_f32 v33, v18, v19
    v_add_f32 v34, v20, v21
    v_add_f32 v35, v22, v23
    v_add_f32 v36, v24, v25
    v_add_f32 v37, v26, v27
    v_add_f32 v38, v28, v29
    v_add_f32 v39, v30, v31
    v_add_f32 v32, v32, v34
    v_add_f32 v33, v33, v35
    v_add_f32 v36, v36, v38
    v_add_f32 v37, v37, v39
    v_add_f32 v32, v32, v33
    v_add_f32 v36, v36, v37
    v_mul_f32 v40, v16, v16
    v_mul_f32 v41, v17, v17
    v_mul_f32 v42, v18, v18
    v_mul_f32 v43, v19, v19
    v_fmac_f32 v40, v20, v20
    v_fmac_f32 v41, v21, v21
    v_fmac_f32 v42, v22, v22
    v_fmac_f32 v43, v23, v23
    v_fmac_f32 v40, v24, v24
    v_fmac_f32 v41, v25, v25
    v_fmac_f32 v42, v26, v26
    v_fmac_f32 v43, v27, v27
    v_fmac_f32 v40, v28, v28
    v_fmac_f32 v41, v29, v29
    v_fmac_f32 v42, v30, v30
    v_fmac_f32 v43, v31, v31
    v_add_f32 v40, v40, v41
    v_add_f32 v42, v42, v43
    v_add_f32 v40, v40, v42
    v_sub_f32 v33, v32, v36
    v_add_f32 v32, v32, v36
    v_add_f32_dpp v40, v40, v40 quad_perm:[1,0,3,2] row_mask:0xf bank_mask:0xf
    s_nop 0
    v_add_f32_dpp v32, v32, v32 quad_perm:[1,0,3,2] row_mask:0xf bank_mask:0xf
    v_add_f32_dpp v33, v33, v33 quad_perm:[1,0,3,2] row_mask:0xf bank_mask:0xf
    v_add_f32_dpp v40, v40, v40 quad_perm:[2,3,0,1] row_mask:0xf bank_mask:0xf
    v_add_f32_dpp v32, v32, v32 quad_perm:[2,3,0,1] row_mask:0xf bank_mask:0xf
    v_add_f32_dpp v33, v33, v33 quad_perm:[2,3,0,1] row_mask:0xf bank_mask:0xf
    v_add_f32_dpp v40, v40, v40 row_half_mirror row_mask:0xf bank_mask:0xf
    v_add_f32_dpp v32, v32, v32 row_half_mirror row_mask:0xf bank_mask:0xf
    v_add_f32_dpp v33, v33, v33 row_half_mirror row_mask:0xf bank_mask:0xf
    v_add_f32_dpp v40, v40, v40 row_mirror row_mask:0xf bank_mask:0xf
    v_add_f32_dpp v32, v32, v32 row_mirror row_mask:0xf bank_mask:0xf
    v_add_f32_dpp v33, v33, v33 row_mirror row_mask:0xf bank_mask:0xf
    v_add_f32_dpp v40, v40, v40 row_bcast:15 row_mask:0xa bank_mask:0xf
    v_add_f32_dpp v32, v32, v32 row_bcast:15 row_mask:0xa bank_mask:0xf
    v_add_f32_dpp v33, v33, v33 row_bcast:15 row_mask:0xa bank_mask:0xf
    v_add_f32_dpp v40, v40, v40 row_bcast:31 row_mask:0xc bank_mask:0xf
    v_add_f32_dpp v32, v32, v32 row_bcast:31 row_mask:0xc bank_mask:0xf
    v_add_f32_dpp v33, v33, v33 row_bcast:31 row_mask:0xc bank_mask:0xf
    v_readlane_b32 s38, v40, 63
    v_readlane_b32 s37, v32, 63
    v_readlane_b32 s39, v33, 63
    v_mov_b32 v44, 0x3a800000
    v_mul_f32 v45, s37, v44
    v_mul_f32 v44, s38, v44
    v_fma_f32 v44, -v45, v45, v44
    v_max_f32 v157, 0, v44
    v_cvt_pk_bf16_f32 v44, 0, v157
    v_add_f32 v44, s62, v44
    v_cvt_pk_bf16_f32 v44, 0, v44
    v_sqrt_f32 v44, v44
    s_nop 0
    v_cvt_pk_bf16_f32 v161, 0, v44
    v_rcp_f32 v44, v161
    v_add_f32 v156, s36, v45
    v_mul_f32 v44, 0x3d000000, v44
    v_mul_f32 v45, -v45, v44
    v_mul_f32 v46, s39, v44
    v_fma_f32 v16, v16, v44, v45
    v_fma_f32 v17, v17, v44, v45
    v_fma_f32 v18, v18, v44, v45
    v_fma_f32 v19, v19, v44, v45
    v_fma_f32 v20, v20, v44, v45
    v_fma_f32 v21, v21, v44, v45
    v_fma_f32 v22, v22, v44, v45
    v_fma_f32 v23, v23, v44, v45
    v_fma_f32 v24, v24, v44, v45
    v_fma_f32 v25, v25, v44, v45
    v_fma_f32 v26, v26, v44, v45
    v_fma_f32 v27, v27, v44, v45
    v_fma_f32 v28, v28, v44, v45
    v_fma_f32 v29, v29, v44, v45
    v_fma_f32 v30, v30, v44, v45
    v_fma_f32 v31, v31, v44, v45
    v_cvt_pk_f16_f32 v159, v46, 0
    v_mul_f32 v46, 0.5, v46
    v_cvt_pk_f16_f32 v46, v46, 0
    ds_write_b32 v166, v46 offset:4096
    v_cvt_pk_f16_f32 v8, v16, v17
    v_cvt_pk_f16_f32 v9, v18, v19
    v_cvt_pk_f16_f32 v10, v20, v21
    v_cvt_pk_f16_f32 v11, v22, v23
    v_cvt_pk_f16_f32 v12, v24, v25
    v_cvt_pk_f16_f32 v13, v26, v27
    v_cvt_pk_f16_f32 v14, v28, v29
    v_cvt_pk_f16_f32 v15, v30, v31
    s_waitcnt lgkmcnt(0)
    v_mfma_f32_16x16x32_f16 v[32:35], v[8:11], v[64:67], 0
    v_mfma_f32_16x16x32_f16 v[36:39], v[8:11], v[68:71], 0
    v_mfma_f32_16x16x32_f16 v[40:43], v[8:11], v[72:75], 0
    v_mfma_f32_16x16x32_f16 v[44:47], v[8:11], v[76:79], 0
    v_mfma_f32_16x16x32_f16 v[48:51], v[12:15], v[64:67], 0
    v_mfma_f32_16x16x32_f16 v[52:55], v[12:15], v[68:71], 0
    v_mfma_f32_16x16x32_f16 v[56:59], v[12:15], v[72:75], 0
    v_mfma_f32_16x16x32_f16 v[60:63], v[12:15], v[76:79], 0
    s_nop 1
    v_mul_f32 v8, v36, v84
    v_mul_f32 v9, v37, v85
    v_mul_f32 v10, v38, v86
    v_mul_f32 v11, v39, v87
    v_mul_f32 v36, v36, v80
    v_mul_f32 v37, v37, v81
    v_mul_f32 v38, v38, v82
    v_mul_f32 v39, v39, v83
    v_fmac_f32 v36, v32, v84
    v_fmac_f32 v37, v33, v85
    v_fmac_f32 v38, v34, v86
    v_fmac_f32 v39, v35, v87
    v_fma_f32 v32, v32, v80, -v8
    v_fma_f32 v33, v33, v81, -v9
    v_fma_f32 v34, v34, v82, -v10
    v_fma_f32 v35, v35, v83, -v11
    v_cvt_pk_f16_f32 v16, v32, v36
    v_cvt_pk_f16_f32 v17, v33, v37
    v_cvt_pk_f16_f32 v18, v34, v38
    v_cvt_pk_f16_f32 v19, v35, v39
    v_mul_f32 v8, v44, v92
    v_mul_f32 v9, v45, v93
    v_mul_f32 v10, v46, v94
    v_mul_f32 v11, v47, v95
    v_mul_f32 v44, v44, v88
    v_mul_f32 v45, v45, v89
    v_mul_f32 v46, v46, v90
    v_mul_f32 v47, v47, v91
    v_fmac_f32 v44, v40, v92
    v_fmac_f32 v45, v41, v93
    v_fmac_f32 v46, v42, v94
    v_fmac_f32 v47, v43, v95
    v_fma_f32 v40, v40, v88, -v8
    v_fma_f32 v41, v41, v89, -v9
    v_fma_f32 v42, v42, v90, -v10
    v_fma_f32 v43, v43, v91, -v11
    v_cvt_pk_f16_f32 v24, v40, v44
    v_cvt_pk_f16_f32 v25, v41, v45
    v_cvt_pk_f16_f32 v26, v42, v46
    v_cvt_pk_f16_f32 v27, v43, v47
    v_mul_f32 v8, v52, v100
    v_mul_f32 v9, v53, v101
    v_mul_f32 v10, v54, v102
    v_mul_f32 v11, v55, v103
    v_mul_f32 v52, v52, v96
    v_mul_f32 v53, v53, v97
    v_mul_f32 v54, v54, v98
    v_mul_f32 v55, v55, v99
    v_fmac_f32 v52, v48, v100
    v_fmac_f32 v53, v49, v101
    v_fmac_f32 v54, v50, v102
    v_fmac_f32 v55, v51, v103
    v_fma_f32 v48, v48, v96, -v8
    v_fma_f32 v49, v49, v97, -v9
    v_fma_f32 v50, v50, v98, -v10
    v_fma_f32 v51, v51, v99, -v11
    v_cvt_pk_f16_f32 v20, v48, v52
    v_cvt_pk_f16_f32 v21, v49, v53
    v_cvt_pk_f16_f32 v22, v50, v54
    v_cvt_pk_f16_f32 v23, v51, v55
    v_mul_f32 v8, v60, v108
    v_mul_f32 v9, v61, v109
    v_mul_f32 v10, v62, v110
    v_mul_f32 v11, v63, v111
    v_mul_f32 v60, v60, v104
    v_mul_f32 v61, v61, v105
    v_mul_f32 v62, v62, v106
    v_mul_f32 v63, v63, v107
    v_fmac_f32 v60, v56, v108
    v_fmac_f32 v61, v57, v109
    v_fmac_f32 v62, v58, v110
    v_fmac_f32 v63, v59, v111
    v_fma_f32 v56, v56, v104, -v8
    v_fma_f32 v57, v57, v105, -v9
    v_fma_f32 v58, v58, v106, -v10
    v_fma_f32 v59, v59, v107, -v11
    v_cvt_pk_f16_f32 v28, v56, v60
    v_cvt_pk_f16_f32 v29, v57, v61
    v_cvt_pk_f16_f32 v30, v58, v62
    v_cvt_pk_f16_f32 v31, v59, v63
    v_mfma_f32_16x16x32_f16 v[64:67], v[112:115], v[16:19], 0
    v_mfma_f32_16x16x32_f16 v[68:71], v[116:119], v[16:19], 0
    v_mfma_f32_16x16x32_f16 v[72:75], v[112:115], v[24:27], 0
    v_mfma_f32_16x16x32_f16 v[76:79], v[116:119], v[24:27], 0
    v_mfma_f32_16x16x32_f16 v[64:67], v[120:123], v[20:23], v[64:67]
    v_mfma_f32_16x16x32_f16 v[68:71], v[124:127], v[20:23], v[68:71]
    v_mfma_f32_16x16x32_f16 v[72:75], v[120:123], v[28:31], v[72:75]
    v_mfma_f32_16x16x32_f16 v[76:79], v[124:127], v[28:31], v[76:79]
    s_nop 5
    v_cvt_pk_f16_f32 v148, v64, v68
    s_nop 0
    v_cvt_pk_f16_f32 v152, v72, v76
    v_cndmask_b32 v148, v148, v159, s[46:47]
    ds_write2_b32 v146, v148, v152 offset0:0 offset1:32
    v_cvt_pk_f16_f32 v149, v65, v69
    v_cvt_pk_f16_f32 v153, v73, v77
    ds_write2_b32 v146, v149, v153 offset0:64 offset1:96
    v_cvt_pk_f16_f32 v150, v66, v70
    v_cvt_pk_f16_f32 v154, v74, v78
    ds_write2_b32 v146, v150, v154 offset0:128 offset1:160
    v_cvt_pk_f16_f32 v151, v67, v71
    v_cvt_pk_f16_f32 v155, v75, v79
    ds_write2_b32 v146, v151, v155 offset0:192 offset1:224
    s_cmp_eq_u32 s101, 1
    s_cbranch_scc1 m_rowh
    s_mov_b64 exec, 1
    ds_add_u32 v164, v165 offset:32
    s_mov_b64 exec, -1
    s_setprio 1
m_b1:
    ds_read_b32 v60, v164 offset:32
    s_waitcnt lgkmcnt(0)
    v_cmp_gt_u32 vcc, 8, v60
    s_add_u32 s58, s58, 1
    s_cmp_gt_u32 s58, 2097152
    s_cbranch_scc1 m_b1_x
    s_cbranch_vccnz m_b1
m_b1_x:
    s_setprio 2
    ds_read_b64 v[16:17], v147 offset:16904
    ds_read_b64 v[18:19], v147 offset:17032
    ds_read_b64 v[20:21], v147 offset:17160
    ds_read_b64 v[22:23], v147 offset:17288
    s_waitcnt lgkmcnt(3)
    v_mfma_f32_16x16x16_f16 v[32:35], v[144:145], v[16:17], 0
    s_waitcnt lgkmcnt(2)
    v_mfma_f32_16x16x16_f16 v[36:39], v[144:145], v[18:19], 0
    s_waitcnt lgkmcnt(1)
    v_mfma_f32_16x16x16_f16 v[40:43], v[144:145], v[20:21], 0
    s_waitcnt lgkmcnt(0)
    v_mfma_f32_16x16x16_f16 v[44:47], v[144:145], v[22:23], 0
    s_nop 1
    v_cvt_pk_f16_f32 v32, v32, v33
    v_cvt_pk_f16_f32 v33, v34, v35
    s_add_u32 s43, s40, 524288
    buffer_store_dword v32, v167, s[24:27], s40 offen sc1
    buffer_store_dword v33, v167, s[24:27], s43 offen sc1
    s_add_u32 s40, s40, 16384
    v_cvt_pk_f16_f32 v36, v36, v37
    v_cvt_pk_f16_f32 v37, v38, v39
    s_add_u32 s43, s40, 524288
    buffer_store_dword v36, v167, s[24:27], s40 offen sc1
    buffer_store_dword v37, v167, s[24:27], s43 offen sc1
    s_add_u32 s40, s40, 16384
    v_cvt_pk_f16_f32 v40, v40, v41
    v_cvt_pk_f16_f32 v41, v42, v43
    s_add_u32 s43, s40, 524288
    buffer_store_dword v40, v167, s[24:27], s40 offen sc1
    buffer_store_dword v41, v167, s[24:27], s43 offen sc1
    s_add_u32 s40, s40, 16384
    v_cvt_pk_f16_f32 v44, v44, v45
    v_cvt_pk_f16_f32 v45, v46, v47
    s_add_u32 s43, s40, 524288
    buffer_store_dword v44, v167, s[24:27], s40 offen sc1
    buffer_store_dword v45, v167, s[24:27], s43 offen sc1
    s_bfe_u32 s34, s30, 0x30001
    s_lshl_b32 s35, s94, 3
    s_add_u32 s34, s34, s35
    s_mul_i32 s34, s34, 256
    s_lshr_b32 s35, s30, 4
    s_lshl_b32 s35, s35, 4
    s_add_u32 s34, s34, s35
    s_and_b32 s35, s30, 1
    s_lshl_b32 s35, s35, 3
    s_add_u32 s34, s34, s35
    s_add_u32 s34, s34, 0x580000
    v_mov_b32 v160, 0
    v_mul_u32_u24 v119, 16384, v1
    s_mov_b64 exec, 1
    ds_add_u32 v164, v165 offset:96
    s_mov_b64 exec, -1
    s_setprio 0
    v_cvt_f32_u32 v16, v2
    v_cvt_f32_u32 v17, v3
    v_cvt_f32_u32 v18, v7
    v_mul_f32 v20, 0x3d800000, v16
    v_mul_f32 v19, 4.0, v17
    v_mul_f32 v21, v19, v20
    v_cos_f32 v22, v21
    v_sin_f32 v23, v21
    v_add_f32 v21, v21, v20
    v_cvt_pk_f16_f32 v56, v22, v23
    v_cvt_pk_f16_f32 v60, -v23, v22
    v_cos_f32 v22, v21
    v_sin_f32 v23, v21
    v_add_f32 v21, v21, v20
    v_cvt_pk_f16_f32 v57, v22, v23
    v_cvt_pk_f16_f32 v61, -v23, v22
    v_cos_f32 v22, v21
    v_sin_f32 v23, v21
    v_add_f32 v21, v21, v20
    v_cvt_pk_f16_f32 v58, v22, v23
    v_cvt_pk_f16_f32 v62, -v23, v22
    v_cos_f32 v22, v21
    v_sin_f32 v23, v21
    s_nop 0
    v_cvt_pk_f16_f32 v59, v22, v23
    v_cvt_pk_f16_f32 v63, -v23, v22
    v_mul_f32 v24, 0x3c000000, v18
    v_add_f32 v25, v24, v20
    v_mul_f32 v21, v19, v25
    v_cos_f32 v22, v21
    v_sin_f32 v23, v21
    v_add_f32 v21, v21, v25
    v_cvt_pk_f16_f32 v64, v22, v23
    v_cvt_pk_f16_f32 v68, -v23, v22
    v_cos_f32 v22, v21
    v_sin_f32 v23, v21
    v_add_f32 v21, v21, v25
    v_cvt_pk_f16_f32 v65, v22, v23
    v_cvt_pk_f16_f32 v69, -v23, v22
    v_cos_f32 v22, v21
    v_sin_f32 v23, v21
    v_add_f32 v21, v21, v25
    v_cvt_pk_f16_f32 v66, v22, v23
    v_cvt_pk_f16_f32 v70, -v23, v22
    v_cos_f32 v22, v21
    v_sin_f32 v23, v21
    s_nop 0
    v_cvt_pk_f16_f32 v67, v22, v23
    v_cvt_pk_f16_f32 v71, -v23, v22
    v_lshlrev_b32 v98, 12, v3
    v_lshl_add_u32 v98, v2, 3, v98
    s_and_b32 s42, s2, 3
    s_bfe_u32 s43, s2, 0x10003
    s_lshl_b32 s41, s42, 1
    s_add_u32 s41, s41, s43
    s_lshr_b32 s35, s2, 4
    s_and_b32 s36, s2, 4
    s_lshl_b32 s36, s36, 2
    s_add_u32 s35, s35, s36
    s_lshr_b32 s61, s35, 2
    s_mul_i32 s32, s41, 524288
    s_mul_i32 s36, s35, 16384
    s_add_u32 s32, s32, s36
    s_mul_i32 s42, s42, 1048576
    s_lshl_b32 s36, s36, 1
    s_add_u32 s42, s42, s36
    s_lshl_b32 s43, s43, 2
    s_add_u32 s42, s42, s43
    s_lshl_b32 s36, s94, 8
    s_add_u32 s42, s42, s36
    s_lshl_b32 s36, s94, 7
    s_add_u32 s32, s32, s36
    s_lshr_b32 s36, s94, 1
    s_lshl_b32 s36, s36, 8
    s_and_b32 s37, s94, 1
    s_lshl_b32 s37, s37, 3
    s_add_u32 s36, s36, s37
    v_lshlrev_b32 v96, 12, v3
    v_lshl_add_u32 v96, v2, 4, v96
    v_add_u32 v96, s36, v96
    s_lshl_b32 s36, s94, 11
    v_add_u32 v97, s36, v5
    s_lshr_b32 s35, s35, 2
    s_lshl_b32 s35, s35, 3
    s_add_u32 s35, s35, s94
    s_and_b32 s37, s41, 3
    s_lshl_b32 s37, s37, 6
    s_add_u32 s35, s35, s37
    s_mul_i32 s35, s35, 256
    s_add_u32 s35, s35, 0x580000
    v_lshlrev_b32 v118, 3, v1
    v_cmp_gt_u32 s[52:53], 32, v1
    v_lshlrev_b32 v112, 12, v3
    v_lshl_add_u32 v112, v2, 2, v112
    s_mov_b32 s36, s42
    s_add_u32 s37, s36, 4096
    v_mov_b32 v32, 0
    v_mov_b32 v33, 0
    v_mov_b32 v34, 0
    v_mov_b32 v35, 0
    v_mov_b32 v36, 0
    v_mov_b32 v37, 0
    v_mov_b32 v38, 0
    v_mov_b32 v39, 0
    v_mov_b32 v40, 0
    v_mov_b32 v41, 0
    v_mov_b32 v42, 0
    v_mov_b32 v43, 0
    v_mov_b32 v44, 0
    v_mov_b32 v45, 0
    v_mov_b32 v46, 0
    v_mov_b32 v47, 0
    v_lshlrev_b32 v113, 11, v3
    v_lshl_add_u32 v113, v2, 1, v113
    s_lshl_b32 s43, s94, 6
    s_add_u32 s43, s43, 99328
    v_add_u32 v113, s43, v113
    s_setprio 2
m_mk:
    ds_read_b32 v120, v164 offset:88
    s_waitcnt lgkmcnt(0)
    v_cmp_gt_u32 vcc, 4, v120
    s_add_u32 s58, s58, 1
    s_cmp_gt_u32 s58, 2097152
    s_cbranch_scc1 m_mk_x
    s_cbranch_vccnz m_mk
m_mk_x:
    ds_read_b32 v120, v164 offset:68
    ds_read_b64 v[158:159], v164 offset:104
    s_waitcnt lgkmcnt(0)
    v_lshrrev_b32 v120, 7, v120
    v_or_b32 v120, v120, v158
    v_mov_b32 v121, v159
    s_waitcnt vmcnt(0)
    s_mov_b64 exec, 15
    buffer_atomic_swap_x2 v[120:121], v119, s[24:27], s34 offen sc1
    s_mov_b64 exec, 1
    ds_add_u32 v164, v165 offset:72
    s_mov_b64 exec, -1
    s_mov_b32 exec_hi, 0
m_p1:
    s_sleep 8
    v_mov_b32 v114, 0
    v_mov_b32 v115, 0
    buffer_atomic_or_x2 v[114:115], v118, s[24:27], s35 offen sc0 sc1
    s_waitcnt vmcnt(0)
    v_and_b32 v116, 0xffffff00, v114
    v_mov_b32 v117, v115
    v_cmp_ne_u64 vcc, v[116:117], v[158:159]
    s_add_u32 s58, s58, 1
    s_cmp_gt_u32 s58, 2097152
    s_cbranch_scc1 m_p1_x
    s_cbranch_vccz m_p1_x
    s_mov_b64 exec, vcc
    s_branch m_p1
m_p1_x:
    s_mov_b64 exec, -1
    s_mov_b64 exec, -1
    s_setprio 2
    buffer_load_dword v8, v112, s[24:27], s32 offen offset:0 sc1
    buffer_load_dword v9, v112, s[24:27], s32 offen offset:1024 sc1
    buffer_load_dword v10, v112, s[24:27], s32 offen offset:2048 sc1
    buffer_load_dword v11, v112, s[24:27], s32 offen offset:3072 sc1
    buffer_load_dword v12, v112, s[24:27], s32 offen offset:64 sc1
    buffer_load_dword v13, v112, s[24:27], s32 offen offset:1088 sc1
    buffer_load_dword v14, v112, s[24:27], s32 offen offset:2112 sc1
    buffer_load_dword v15, v112, s[24:27], s32 offen offset:3136 sc1
    s_setprio 1
    v_mul_f32 v24, 0x3c000000, v18
    v_add_f32 v24, 0x3b800000, v24
    v_add_f32 v25, v24, v20
    v_mul_f32 v21, v19, v25
    v_cos_f32 v22, v21
    v_sin_f32 v23, v21
    v_add_f32 v21, v21, v25
    v_cvt_pk_f16_f32 v72, v22, v23
    v_cvt_pk_f16_f32 v76, -v23, v22
    v_cos_f32 v22, v21
    v_sin_f32 v23, v21
    v_add_f32 v21, v21, v25
    v_cvt_pk_f16_f32 v73, v22, v23
    v_cvt_pk_f16_f32 v77, -v23, v22
    v_cos_f32 v22, v21
    v_sin_f32 v23, v21
    v_add_f32 v21, v21, v25
    v_cvt_pk_f16_f32 v74, v22, v23
    v_cvt_pk_f16_f32 v78, -v23, v22
    v_cos_f32 v22, v21
    v_sin_f32 v23, v21
    s_nop 0
    v_cvt_pk_f16_f32 v75, v22, v23
    v_cvt_pk_f16_f32 v79, -v23, v22
m_w:
    ds_read_b32 v116, v164 offset:92
    s_waitcnt lgkmcnt(0)
    v_cmp_gt_u32 vcc, 4, v116
    s_add_u32 s58, s58, 1
    s_cmp_gt_u32 s58, 2097152
    s_cbranch_scc1 m_w_x
    s_cbranch_vccnz m_w
m_w_x:
    ds_read_u16_d16_hi v32, v113 offset:0
    ds_read_u16_d16_hi v40, v113 offset:8192
    ds_read_u16_d16_hi v33, v113 offset:512
    ds_read_u16_d16_hi v41, v113 offset:8704
    ds_read_u16_d16_hi v34, v113 offset:1024
    ds_read_u16_d16_hi v42, v113 offset:9216
    ds_read_u16_d16_hi v35, v113 offset:1536
    ds_read_u16_d16_hi v43, v113 offset:9728
    ds_read_u16_d16_hi v36, v113 offset:32
    ds_read_u16_d16_hi v44, v113 offset:8224
    ds_read_u16_d16_hi v37, v113 offset:544
    ds_read_u16_d16_hi v45, v113 offset:8736
    ds_read_u16_d16_hi v38, v113 offset:1056
    ds_read_u16_d16_hi v46, v113 offset:9248
    ds_read_u16_d16_hi v39, v113 offset:1568
    ds_read_u16_d16_hi v47, v113 offset:9760
    v_and_b32 v114, 0xff, v114
    s_nop 1
    v_max_u32_dpp v114, v114, v114 quad_perm:[1,0,3,2] row_mask:0xf bank_mask:0xf
    s_nop 1
    v_max_u32_dpp v114, v114, v114 quad_perm:[2,3,0,1] row_mask:0xf bank_mask:0xf
    s_nop 1
    v_max_u32_dpp v114, v114, v114 row_half_mirror row_mask:0xf bank_mask:0xf
    s_nop 1
    v_max_u32_dpp v114, v114, v114 row_mirror row_mask:0xf bank_mask:0xf
    s_mov_b64 exec, 0x00010001
    ds_max_u32 v164, v114 offset:64
    s_mov_b64 exec, 1
    ds_add_u32 v164, v165 offset:56
    s_mov_b64 exec, -1
    s_setprio 2
    s_waitcnt vmcnt(4)
    v_mfma_f32_16x16x32_f16 v[112:115], v[56:59], v[8:11], 0
    v_mfma_f32_16x16x32_f16 v[116:119], v[60:63], v[8:11], 0
    s_waitcnt vmcnt(0)
    v_mfma_f32_16x16x32_f16 v[120:123], v[56:59], v[12:15], 0
    v_mfma_f32_16x16x32_f16 v[124:127], v[60:63], v[12:15], 0
    s_nop 4
    v_cvt_pk_f16_f32 v100, v112, v116
    s_nop 1
    v_cvt_pk_f16_f32 v101, v120, v124
    ds_write_b64 v96, v[100:101] offset:0
    v_cvt_pk_f16_f32 v102, v113, v117
    v_cvt_pk_f16_f32 v103, v121, v125
    ds_write_b64 v96, v[102:103] offset:1024
    v_cvt_pk_f16_f32 v104, v114, v118
    v_cvt_pk_f16_f32 v105, v122, v126
    ds_write_b64 v96, v[104:105] offset:2048
    v_cvt_pk_f16_f32 v106, v115, v119
    v_cvt_pk_f16_f32 v107, v123, v127
    ds_write_b64 v96, v[106:107] offset:3072
    s_mov_b64 exec, 1
    ds_add_u32 v164, v165 offset:36
    s_mov_b64 exec, -1
    buffer_load_dword v136, v4, s[16:19], 0 offen offset:0
    buffer_load_dword v137, v4, s[16:19], 0 offen offset:256
    buffer_load_dword v138, v4, s[16:19], 0 offen offset:512
    buffer_load_dword v139, v4, s[16:19], 0 offen offset:768
    buffer_load_dword v140, v4, s[16:19], 0 offen offset:1024
    buffer_load_dword v141, v4, s[16:19], 0 offen offset:1280
    buffer_load_dword v142, v4, s[16:19], 0 offen offset:1536
    buffer_load_dword v143, v4, s[16:19], 0 offen offset:1792
    s_setprio 1
    v_mul_f32 v21, v19, v20
    v_fmac_f32 v21, v16, v24
    v_cos_f32 v22, v21
    v_sin_f32 v23, v21
    v_add_f32 v21, v21, v20
    v_cvt_pk_f16_f32 v88, v22, -v23
    v_cvt_pk_f16_f32 v92, v23, v22
    v_cos_f32 v22, v21
    v_sin_f32 v23, v21
    v_add_f32 v21, v21, v20
    v_cvt_pk_f16_f32 v89, v22, -v23
    v_cvt_pk_f16_f32 v93, v23, v22
    v_cos_f32 v22, v21
    v_sin_f32 v23, v21
    v_add_f32 v21, v21, v20
    v_cvt_pk_f16_f32 v90, v22, -v23
    v_cvt_pk_f16_f32 v94, v23, v22
    v_cos_f32 v22, v21
    v_sin_f32 v23, v21
    s_nop 0
    v_cvt_pk_f16_f32 v91, v22, -v23
    v_cvt_pk_f16_f32 v95, v23, v22
    v_add_f32 v24, 0xbb800000, v24
    v_mul_f32 v21, v19, v20
    v_fmac_f32 v21, v16, v24
    v_cos_f32 v22, v21
    v_sin_f32 v23, v21
    v_add_f32 v21, v21, v20
    v_cvt_pk_f16_f32 v80, v22, -v23
    v_cvt_pk_f16_f32 v84, v23, v22
    v_cos_f32 v22, v21
    v_sin_f32 v23, v21
    v_add_f32 v21, v21, v20
    v_cvt_pk_f16_f32 v81, v22, -v23
    v_cvt_pk_f16_f32 v85, v23, v22
    v_cos_f32 v22, v21
    v_sin_f32 v23, v21
    v_add_f32 v21, v21, v20
    v_cvt_pk_f16_f32 v82, v22, -v23
    v_cvt_pk_f16_f32 v86, v23, v22
    v_cos_f32 v22, v21
    v_sin_f32 v23, v21
    s_nop 0
    v_cvt_pk_f16_f32 v83, v22, -v23
    v_cvt_pk_f16_f32 v87, v23, v22
    s_setprio 1
m_b2:
    ds_read_b32 v115, v164 offset:36
    s_waitcnt lgkmcnt(0)
    v_cmp_gt_u32 vcc, 8, v115
    s_add_u32 s58, s58, 1
    s_cmp_gt_u32 s58, 2097152
    s_cbranch_scc1 m_b2_x
    s_cbranch_vccnz m_b2
m_b2_x:
    s_setprio 2
    ds_read_b32 v114, v164 offset:64
    ds_read_b128 v[8:11], v97 offset:0
    ds_read_b128 v[12:15], v97 offset:1024
    s_waitcnt lgkmcnt(2)
    v_readfirstlane_b32 s38, v114
    s_nop 0
    s_max_u32 s38, s38, 16
    s_min_u32 s38, s38, 240
    s_sub_u32 s48, 246, s38
    s_lshl_b32 s48, s48, 23
    s_sub_u32 s44, s38, 5
    s_lshl_b32 s44, s44, 23
    s_waitcnt lgkmcnt(1)
    v_mfma_f32_16x16x32_f16 v[16:19], v[64:67], v[8:11], 0
    v_mfma_f32_16x16x32_f16 v[20:23], v[68:71], v[8:11], 0
    s_waitcnt lgkmcnt(0)
    v_mfma_f32_16x16x32_f16 v[24:27], v[72:75], v[12:15], 0
    v_mfma_f32_16x16x32_f16 v[28:31], v[76:79], v[12:15], 0
    v_mul_f32 v32, s48, v32
    v_mul_f32 v33, s48, v33
    v_mul_f32 v34, s48, v34
    v_mul_f32 v35, s48, v35
    v_mul_f32 v36, s48, v36
    v_mul_f32 v37, s48, v37
    v_mul_f32 v38, s48, v38
    v_mul_f32 v39, s48, v39
    v_mul_f32 v40, s48, v40
    v_mul_f32 v41, s48, v41
    v_mul_f32 v42, s48, v42
    v_mul_f32 v43, s48, v43
    v_mul_f32 v44, s48, v44
    v_mul_f32 v45, s48, v45
    v_mul_f32 v46, s48, v46
    v_mul_f32 v47, s48, v47
    v_mul_f32 v108, v20, v40
    v_mul_f32 v109, v21, v41
    v_mul_f32 v110, v22, v42
    v_mul_f32 v111, v23, v43
    v_mul_f32 v20, v20, v32
    v_mul_f32 v21, v21, v33
    v_mul_f32 v22, v22, v34
    v_mul_f32 v23, v23, v35
    v_fmac_f32 v20, v16, v40
    v_fmac_f32 v21, v17, v41
    v_fmac_f32 v22, v18, v42
    v_fmac_f32 v23, v19, v43
    v_fma_f32 v16, v16, v32, -v108
    v_fma_f32 v17, v17, v33, -v109
    v_fma_f32 v18, v18, v34, -v110
    v_fma_f32 v19, v19, v35, -v111
    v_cvt_pk_f16_f32 v8, v16, v20
    v_cvt_pk_f16_f32 v9, v17, v21
    v_cvt_pk_f16_f32 v10, v18, v22
    v_cvt_pk_f16_f32 v11, v19, v23
    s_nop 1
    v_mfma_f32_16x16x32_f16 v[16:19], v[80:83], v[8:11], 0
    v_mfma_f32_16x16x32_f16 v[20:23], v[84:87], v[8:11], 0
    v_mul_f32 v108, v28, v44
    v_mul_f32 v109, v29, v45
    v_mul_f32 v110, v30, v46
    v_mul_f32 v111, v31, v47
    v_mul_f32 v28, v28, v36
    v_mul_f32 v29, v29, v37
    v_mul_f32 v30, v30, v38
    v_mul_f32 v31, v31, v39
    v_fmac_f32 v28, v24, v44
    v_fmac_f32 v29, v25, v45
    v_fmac_f32 v30, v26, v46
    v_fmac_f32 v31, v27, v47
    v_fma_f32 v24, v24, v36, -v108
    v_fma_f32 v25, v25, v37, -v109
    v_fma_f32 v26, v26, v38, -v110
    v_fma_f32 v27, v27, v39, -v111
    v_cvt_pk_f16_f32 v12, v24, v28
    v_cvt_pk_f16_f32 v13, v25, v29
    v_cvt_pk_f16_f32 v14, v26, v30
    v_cvt_pk_f16_f32 v15, v27, v31
    s_nop 1
    v_mfma_f32_16x16x32_f16 v[24:27], v[88:91], v[12:15], 0
    v_mfma_f32_16x16x32_f16 v[28:31], v[92:95], v[12:15], 0
    v_cvt_pk_f16_f32 v100, v20, v16
    s_nop 6
    v_cvt_pk_f16_f32 v101, v28, v24
    ds_write_b64 v96, v[100:101] offset:16896
    v_cvt_pk_f16_f32 v102, v21, v17
    v_cvt_pk_f16_f32 v103, v29, v25
    ds_write_b64 v96, v[102:103] offset:17920
    v_cvt_pk_f16_f32 v104, v22, v18
    v_cvt_pk_f16_f32 v105, v30, v26
    ds_write_b64 v96, v[104:105] offset:18944
    v_cvt_pk_f16_f32 v106, v23, v19
    v_cvt_pk_f16_f32 v107, v31, v27
    ds_write_b64 v96, v[106:107] offset:19968
    s_add_u32 s32, s32, 0x0
    s_mov_b64 exec, 1
    ds_add_u32 v164, v165 offset:40
    s_mov_b64 exec, -1
    s_setprio 1
m_b3:
    ds_read_b32 v114, v164 offset:40
    s_waitcnt lgkmcnt(0)
    v_cmp_gt_u32 vcc, 8, v114
    s_add_u32 s58, s58, 1
    s_cmp_gt_u32 s58, 2097152
    s_cbranch_scc1 m_b3_x
    s_cbranch_vccnz m_b3
m_b3_x:
    s_setprio 2
    ds_read_b128 v[8:11], v97 offset:16896
    ds_read_b128 v[12:15], v97 offset:17920
    s_waitcnt lgkmcnt(1)
    v_mfma_f32_16x16x32_f16 v[16:19], v[60:63], v[8:11], 0
    v_mfma_f32_16x16x32_f16 v[20:23], v[56:59], v[8:11], 0
    s_waitcnt lgkmcnt(0)
    v_mfma_f32_16x16x32_f16 v[24:27], v[60:63], v[12:15], 0
    v_mfma_f32_16x16x32_f16 v[28:31], v[56:59], v[12:15], 0
    s_nop 4
    v_cvt_pk_f16_f32 v100, v16, v20
    s_nop 1
    v_cvt_pk_f16_f32 v101, v24, v28
    buffer_store_dwordx2 v[100:101], v98, s[24:27], s32 offen offset:0 sc1
    v_cvt_pk_f16_f32 v102, v17, v21
    v_cvt_pk_f16_f32 v103, v25, v29
    buffer_store_dwordx2 v[102:103], v98, s[24:27], s32 offen offset:1024 sc1
    v_cvt_pk_f16_f32 v104, v18, v22
    v_cvt_pk_f16_f32 v105, v26, v30
    buffer_store_dwordx2 v[104:105], v98, s[24:27], s32 offen offset:2048 sc1
    v_cvt_pk_f16_f32 v106, v19, v23
    v_cvt_pk_f16_f32 v107, v27, v31
    buffer_store_dwordx2 v[106:107], v98, s[24:27], s32 offen offset:3072 sc1
    s_setprio 0
    v_subrev_u32 v146, 16896, v146
    v_mov_b32 v166, s56
    s_getreg_b32 s56, hwreg(HW_REG_XCC_ID, 0, 4)
    s_add_u32 s56, s56, 1
    v_lshrrev_b32 v32, 1, v2
    v_and_b32 v33, 1, v2
    v_cvt_f32_u32 v33, v33
    v_mul_f32 v33, 0.5, v33
    v_mul_f32 v33, 0.5, v33
    v_lshlrev_b32 v34, 8, v32
    v_add_u32 v34, s30, v34
    v_lshlrev_b32 v35, 1, v3
    v_mul_u32_u24 v34, v34, v35
    v_and_b32 v34, 0x7ff, v34
    v_cvt_f32_u32 v34, v34
    v_mul_f32 v34, 0xba000000, v34
    v_add_f32 v34, v34, v33
    v_cos_f32 v35, v34
    v_sin_f32 v34, v34
    s_nop 0
    v_cvt_pk_f16_f32 v144, v35, v34
    v_lshlrev_b32 v34, 8, v32
    v_add_u32 v34, s30, v34
    v_lshlrev_b32 v35, 1, v3
    v_add_u32 v35, 1, v35
    v_mul_u32_u24 v34, v34, v35
    v_and_b32 v34, 0x7ff, v34
    v_cvt_f32_u32 v34, v34
    v_mul_f32 v34, 0xba000000, v34
    v_add_f32 v34, v34, v33
    v_cos_f32 v35, v34
    v_sin_f32 v34, v34
    s_nop 0
    v_cvt_pk_f16_f32 v145, v35, v34
    v_add_u32 v36, 33792, v5
    ds_read_b128 v[64:67], v36 offset:0
    ds_read_b128 v[68:71], v36 offset:1024
    ds_read_b128 v[72:75], v36 offset:2048
    ds_read_b128 v[76:79], v36 offset:3072
    ds_read_b128 v[80:83], v36 offset:4096
    ds_read_b128 v[84:87], v36 offset:5120
    ds_read_b128 v[88:91], v36 offset:6144
    ds_read_b128 v[92:95], v36 offset:7168
    ds_read_b128 v[96:99], v36 offset:8192
    ds_read_b128 v[100:103], v36 offset:9216
    ds_read_b128 v[104:107], v36 offset:10240
    ds_read_b128 v[108:111], v36 offset:11264
    ds_read_b128 v[112:115], v36 offset:12288
    ds_read_b128 v[116:119], v36 offset:13312
    ds_read_b128 v[120:123], v36 offset:14336
    ds_read_b128 v[124:127], v36 offset:15360
    s_mov_b32 s48, 0x3f803f80
    s_waitcnt vmcnt(4)
    v_dot2_f32_bf16 v62, v136, s48, 0
    v_dot2_f32_bf16 v63, v136, v128, 0
    v_dot2_f32_bf16 v62, v137, s48, v62
    v_dot2_f32_bf16 v63, v137, v129, v63
    v_dot2_f32_bf16 v62, v138, s48, v62
    v_dot2_f32_bf16 v63, v138, v130, v63
    v_dot2_f32_bf16 v62, v139, s48, v62
    v_dot2_f32_bf16 v63, v139, v131, v63
    v_dot2_f32_bf16 v62, v140, s48, v62
    v_dot2_f32_bf16 v63, v140, v132, v63
    v_dot2_f32_bf16 v62, v141, s48, v62
    v_dot2_f32_bf16 v63, v141, v133, v63
    v_dot2_f32_bf16 v62, v142, s48, v62
    v_dot2_f32_bf16 v63, v142, v134, v63
    v_dot2_f32_bf16 v62, v143, s48, v62
    v_dot2_f32_bf16 v63, v143, v135, v63
    v_and_b32 v136, 0xffff0000, v128
    v_lshlrev_b32 v128, 16, v128
    v_and_b32 v137, 0xffff0000, v129
    v_lshlrev_b32 v129, 16, v129
    v_and_b32 v138, 0xffff0000, v130
    v_lshlrev_b32 v130, 16, v130
    v_and_b32 v139, 0xffff0000, v131
    v_lshlrev_b32 v131, 16, v131
    v_and_b32 v140, 0xffff0000, v132
    v_lshlrev_b32 v132, 16, v132
    v_and_b32 v141, 0xffff0000, v133
    v_lshlrev_b32 v133, 16, v133
    v_and_b32 v142, 0xffff0000, v134
    v_lshlrev_b32 v134, 16, v134
    v_and_b32 v143, 0xffff0000, v135
    v_lshlrev_b32 v135, 16, v135
    v_sub_f32 v128, v128, v156
    v_sub_f32 v129, v129, v156
    v_sub_f32 v130, v130, v156
    v_sub_f32 v131, v131, v156
    v_sub_f32 v132, v132, v156
    v_sub_f32 v133, v133, v156
    v_sub_f32 v134, v134, v156
    v_sub_f32 v135, v135, v156
    v_sub_f32 v136, v136, v156
    v_sub_f32 v137, v137, v156
    v_sub_f32 v138, v138, v156
    v_sub_f32 v139, v139, v156
    v_sub_f32 v140, v140, v156
    v_sub_f32 v141, v141, v156
    v_sub_f32 v142, v142, v156
    v_sub_f32 v143, v143, v156
    s_bfe_u32 s35, s30, 0x30001
    s_lshl_b32 s35, s35, 3
    s_add_u32 s35, s35, s94
    s_mul_i32 s35, s35, 128
    s_add_u32 s35, s35, 0x480000
    s_lshr_b32 s36, s30, 4
    s_and_b32 s36, s36, 1
    s_mul_i32 s36, s36, 8192
    s_add_u32 s35, s35, s36
    s_add_u32 s40, s33, 0x0
    s_lshl_b32 s34, s94, 3
    s_add_u32 s34, s34, s61
    s_mul_i32 s34, s34, 128
    s_add_u32 s34, s34, 0x480000
    s_setprio 2
m_f:
    ds_read_b32 v36, v164 offset:60
    s_waitcnt lgkmcnt(0)
    v_cmp_gt_u32 vcc, 4, v36
    s_add_u32 s58, s58, 1
    s_cmp_gt_u32 s58, 2097152
    s_cbranch_scc1 m_f_x
    s_cbranch_vccnz m_f
m_f_x:
    s_waitcnt vmcnt(0)
    v_mul_u32_u24 v52, 8192, v1
    s_mov_b64 exec, 3
    buffer_atomic_add v165, v52, s[24:27], s34 offen sc1
    s_mov_b64 exec, 1
    ds_add_u32 v164, v165 offset:76
    s_mov_b64 exec, -1
    s_mov_b64 exec, 1
m_p2:
    v_mov_b32 v36, 0
    buffer_atomic_or v36, v160, s[24:27], s35 offen sc0 sc1
    s_waitcnt vmcnt(0)
    v_cmp_gt_u32 vcc, 32, v36
    s_add_u32 s58, s58, 1
    s_cmp_gt_u32 s58, 2097152
    s_cbranch_scc1 m_p2_x
    s_cbranch_vccz m_p2_x
    s_sleep 2
    s_branch m_p2
m_p2_x:
    s_mov_b64 exec, -1
    s_setprio 2
    s_add_u32 s43, s40, 524288
    buffer_load_dword v16, v6, s[24:27], s40 offen sc1
    buffer_load_dword v17, v6, s[24:27], s43 offen sc1
    s_add_u32 s40, s40, 16384
    s_add_u32 s43, s40, 524288
    buffer_load_dword v18, v6, s[24:27], s40 offen sc1
    buffer_load_dword v19, v6, s[24:27], s43 offen sc1
    s_add_u32 s40, s40, 16384
    s_add_u32 s43, s40, 524288
    buffer_load_dword v20, v6, s[24:27], s40 offen sc1
    buffer_load_dword v21, v6, s[24:27], s43 offen sc1
    s_add_u32 s40, s40, 16384
    s_add_u32 s43, s40, 524288
    buffer_load_dword v22, v6, s[24:27], s40 offen sc1
    buffer_load_dword v23, v6, s[24:27], s43 offen sc1
    s_mov_b64 exec, 1
    ds_add_u32 v164, v165 offset:52
    s_mov_b64 exec, -1
    s_setprio 1
m_rs:
    ds_read_b32 v56, v164 offset:112
    s_waitcnt lgkmcnt(0)
    v_cmp_gt_u32 vcc, 1, v56
    s_add_u32 s58, s58, 1
    s_cmp_gt_u32 s58, 2097152
    s_cbranch_scc1 m_rs_x
    s_cbranch_vccnz m_rs
m_rs_x:
    v_lshlrev_b32 v56, 10, v3
    v_lshl_add_u32 v56, v2, 3, v56
    v_add_u32 v56, 148992, v56
    ds_read2_b32 v[48:49], v56 offset0:0 offset1:64
    ds_read2_b32 v[50:51], v56 offset0:128 offset1:192
    ds_read2_b32 v[52:53], v56 offset0:32 offset1:96
    ds_read2_b32 v[54:55], v56 offset0:160 offset1:224
    v_lshrrev_b32 v158, 3, v1
    v_lshl_add_u32 v158, v158, 2, v164
    v_and_b32 v159, 28, v4
    v_add_u32 v159, v159, v164
    v_and_b32 v163, 56, v1
    ds_read_b32 v59, v164 offset:116
    v_add_f32_dpp v62, v62, v62 quad_perm:[1,0,3,2] row_mask:0xf bank_mask:0xf
    v_add_f32_dpp v63, v63, v63 quad_perm:[1,0,3,2] row_mask:0xf bank_mask:0xf
    s_nop 0
    v_add_f32_dpp v62, v62, v62 quad_perm:[2,3,0,1] row_mask:0xf bank_mask:0xf
    v_add_f32_dpp v63, v63, v63 quad_perm:[2,3,0,1] row_mask:0xf bank_mask:0xf
    s_nop 0
    v_add_f32_dpp v62, v62, v62 row_half_mirror row_mask:0xf bank_mask:0xf
    v_add_f32_dpp v63, v63, v63 row_half_mirror row_mask:0xf bank_mask:0xf
    s_nop 0
    v_add_f32_dpp v62, v62, v62 row_mirror row_mask:0xf bank_mask:0xf
    v_add_f32_dpp v63, v63, v63 row_mirror row_mask:0xf bank_mask:0xf
    s_nop 0
    v_add_f32_dpp v62, v62, v62 row_bcast:15 row_mask:0xa bank_mask:0xf
    v_add_f32_dpp v63, v63, v63 row_bcast:15 row_mask:0xa bank_mask:0xf
    s_nop 0
    v_add_f32_dpp v62, v62, v62 row_bcast:31 row_mask:0xc bank_mask:0xf
    v_add_f32_dpp v63, v63, v63 row_bcast:31 row_mask:0xc bank_mask:0xf
    v_readlane_b32 s63, v62, 63
    v_readlane_b32 s60, v63, 63
    v_mov_b32 v57, s44
    v_mul_f32 v58, v57, v161
    v_mul_f32 v58, 0x3c800000, v58
    v_mul_f32 v63, 0x41000000, v57
    v_mul_f32 v57, v57, v57
    v_mul_f32 v57, 0x3d000000, v57
    v_mov_b32 v61, s60
    v_cvt_pk_bf16_f32 v62, 0, v156
    v_fma_f32 v61, -v62, s63, v61
    v_sub_f32 v62, v156, v62
    s_waitcnt lgkmcnt(0)
    v_mul_f32 v59, v59, v63
    s_setprio 2
    s_waitcnt vmcnt(6)
    v_mfma_f32_16x16x16_f16 v[32:35], v[144:145], v[16:17], 0
    s_waitcnt vmcnt(4)
    v_mfma_f32_16x16x16_f16 v[36:39], v[144:145], v[18:19], 0
    s_waitcnt vmcnt(2)
    v_mfma_f32_16x16x16_f16 v[40:43], v[144:145], v[20:21], 0
    s_waitcnt vmcnt(0)
    v_mfma_f32_16x16x16_f16 v[44:47], v[144:145], v[22:23], 0
    s_nop 1
    v_cvt_pk_f16_f32 v32, v32, v33
    v_cvt_pk_f16_f32 v33, v34, v35
    ds_write_b64 v147, v[32:33] offset:8
    v_cvt_pk_f16_f32 v36, v36, v37
    v_cvt_pk_f16_f32 v37, v38, v39
    ds_write_b64 v147, v[36:37] offset:136
    v_cvt_pk_f16_f32 v40, v40, v41
    v_cvt_pk_f16_f32 v41, v42, v43
    ds_write_b64 v147, v[40:41] offset:264
    v_cvt_pk_f16_f32 v44, v44, v45
    v_cvt_pk_f16_f32 v45, v46, v47
    ds_write_b64 v147, v[44:45] offset:392
    s_mov_b64 exec, 1
    ds_add_u32 v164, v165 offset:44
    s_mov_b64 exec, -1
    s_setprio 1
m_b4:
    ds_read_b32 v60, v164 offset:44
    s_waitcnt lgkmcnt(0)
    v_cmp_gt_u32 vcc, 8, v60
    s_add_u32 s58, s58, 1
    s_cmp_gt_u32 s58, 2097152
    s_cbranch_scc1 m_b4_x
    s_cbranch_vccnz m_b4
m_b4_x:
    s_setprio 2
    ds_read_b32 v162, v166
    ds_read2_b32 v[8:9], v146 offset0:0 offset1:64
    ds_read2_b32 v[10:11], v146 offset0:128 offset1:192
    ds_read2_b32 v[12:13], v146 offset0:32 offset1:96
    ds_read2_b32 v[14:15], v146 offset0:160 offset1:224
    s_waitcnt lgkmcnt(0)
    v_and_b32 v162, 0xffff, v162
    v_cndmask_b32 v8, v8, v162, s[46:47]
    v_dot2_f32_f16 v24, v9, v9, 0
    v_dot2_f32_f16 v25, v9, v149, 0
    v_dot2_f32_f16 v26, v9, v49, 0
    v_dot2_f32_f16 v24, v10, v10, v24
    v_dot2_f32_f16 v25, v10, v150, v25
    v_dot2_f32_f16 v26, v10, v50, v26
    v_dot2_f32_f16 v24, v11, v11, v24
    v_dot2_f32_f16 v25, v11, v151, v25
    v_dot2_f32_f16 v26, v11, v51, v26
    v_dot2_f32_f16 v24, v12, v12, v24
    v_dot2_f32_f16 v25, v12, v152, v25
    v_dot2_f32_f16 v26, v12, v52, v26
    v_dot2_f32_f16 v24, v13, v13, v24
    v_dot2_f32_f16 v25, v13, v153, v25
    v_dot2_f32_f16 v26, v13, v53, v26
    v_dot2_f32_f16 v24, v14, v14, v24
    v_dot2_f32_f16 v25, v14, v154, v25
    v_dot2_f32_f16 v26, v14, v54, v26
    v_dot2_f32_f16 v24, v15, v15, v24
    v_dot2_f32_f16 v25, v15, v155, v25
    v_dot2_f32_f16 v26, v15, v55, v26
    v_dot2_f32_f16 v24, v8, v8, v24
    v_dot2_f32_f16 v25, v8, v148, v25
    v_dot2_f32_f16 v26, v8, v48, v26
    v_cvt_f32_f16 v162, v162
    v_add_f32_dpp v24, v24, v24 quad_perm:[1,0,3,2] row_mask:0xf bank_mask:0xf
    v_add_f32_dpp v25, v25, v25 quad_perm:[1,0,3,2] row_mask:0xf bank_mask:0xf
    v_add_f32_dpp v26, v26, v26 quad_perm:[1,0,3,2] row_mask:0xf bank_mask:0xf
    v_add_f32_dpp v24, v24, v24 quad_perm:[2,3,0,1] row_mask:0xf bank_mask:0xf
    v_add_f32_dpp v25, v25, v25 quad_perm:[2,3,0,1] row_mask:0xf bank_mask:0xf
    v_add_f32_dpp v26, v26, v26 quad_perm:[2,3,0,1] row_mask:0xf bank_mask:0xf
    v_add_f32_dpp v24, v24, v24 row_half_mirror row_mask:0xf bank_mask:0xf
    v_add_f32_dpp v25, v25, v25 row_half_mirror row_mask:0xf bank_mask:0xf
    v_add_f32_dpp v26, v26, v26 row_half_mirror row_mask:0xf bank_mask:0xf
    v_add_f32_dpp v24, v24, v24 row_mirror row_mask:0xf bank_mask:0xf
    v_add_f32_dpp v25, v25, v25 row_mirror row_mask:0xf bank_mask:0xf
    v_add_f32_dpp v26, v26, v26 row_mirror row_mask:0xf bank_mask:0xf
    v_add_f32_dpp v24, v24, v24 row_bcast:15 row_mask:0xa bank_mask:0xf
    v_add_f32_dpp v25, v25, v25 row_bcast:15 row_mask:0xa bank_mask:0xf
    v_add_f32_dpp v26, v26, v26 row_bcast:15 row_mask:0xa bank_mask:0xf
    v_add_f32_dpp v24, v24, v24 row_bcast:31 row_mask:0xc bank_mask:0xf
    v_add_f32_dpp v25, v25, v25 row_bcast:31 row_mask:0xc bank_mask:0xf
    v_add_f32_dpp v26, v26, v26 row_bcast:31 row_mask:0xc bank_mask:0xf
    v_readlane_b32 s38, v24, 63
    v_readlane_b32 s39, v25, 63
    v_readlane_b32 s49, v26, 63
    v_fma_f32 v148, v162, v162, s38
    v_fma_f32 v148, v148, v57, v157
    v_fma_f32 v148, s39, v58, v148
    v_fma_f32 v152, s49, v59, v61
    v_max_f32 v148, 0, v148
    v_cvt_pk_bf16_f32 v148, 0, v148
    v_add_f32 v148, 0x3727c5ac, v148
    v_cvt_pk_bf16_f32 v148, 0, v148
    v_sqrt_f32 v148, v148
    s_nop 0
    v_cvt_pk_bf16_f32 v148, 0, v148
    v_rcp_f32 v148, v148
    s_nop 0
    v_mul_f32 v152, v152, v148
    v_mul_f32 v149, v62, v148
    v_ashrrev_i32 v24, 31, v152
    v_or_b32 v24, 0x80000000, v24
    v_xor_b32 v152, v152, v24
    v_and_b32 v152, 0xfffff000, v152
    s_sub_u32 s39, 4095, s45
    v_or_b32 v152, s39, v152
    s_lshl_b32 s35, s94, 2
    v_add_u32 v24, s35, v164
    ds_write_b32 v24, v152
    v_add_u32 v153, v164, v4
    s_mov_b64 exec, 1
    ds_add_rtn_u32 v26, v164, v165 offset:48
    s_mov_b64 exec, -1
    ds_read_b32 v24, v158
    ds_read_b32 v27, v159
    s_lshl_b32 s39, s2, 7
    s_add_u32 s39, s39, 0xed0000
    s_waitcnt lgkmcnt(0)
    v_readfirstlane_b32 s38, v26
    s_nop 0
    s_cmp_lg_u32 s38, 7
    s_cbranch_scc1 k3_nopub
    v_cmp_gt_u32 vcc, v27, v24
    s_nop 1
    v_lshrrev_b64 v[28:29], v163, vcc
    v_and_b32 v28, 0xff, v28
    v_bcnt_u32_b32 v28, v28, 0
    v_lshlrev_b32 v28, 2, v28
    v_writelane_b32 v24, s56, 1
    v_writelane_b32 v28, 32, 1
    s_mov_b32 exec_lo, 0x01010103
    s_mov_b32 exec_hi, 0x01010101
    buffer_store_dword v24, v28, s[24:27], s39 offen sc1
    s_mov_b32 exec_hi, 0
    s_lshr_b32 s39, s2, 5
    s_mul_i32 s39, s39, 1024
    s_add_u32 s39, s39, 0x488000
    s_mov_b32 exec_lo, 0xff
    v_mul_u32_u24 v25, 128, v1
    buffer_atomic_add v165, v25, s[24:27], s39 offen sc1
    s_mov_b64 exec, 1
    ds_add_u32 v164, v165 offset:48
    s_mov_b64 exec, -1
k3_nopub:
    s_setprio 1
    v_mfma_f32_16x16x32_f16 v[32:35], v[8:11], v[64:67], 0
    v_mfma_f32_16x16x32_f16 v[36:39], v[8:11], v[68:71], 0
    v_mfma_f32_16x16x32_f16 v[40:43], v[8:11], v[72:75], 0
    v_mfma_f32_16x16x32_f16 v[44:47], v[8:11], v[76:79], 0
    v_mfma_f32_16x16x32_f16 v[48:51], v[12:15], v[64:67], 0
    v_mfma_f32_16x16x32_f16 v[52:55], v[12:15], v[68:71], 0
    v_mfma_f32_16x16x32_f16 v[56:59], v[12:15], v[72:75], 0
    v_mfma_f32_16x16x32_f16 v[60:63], v[12:15], v[76:79], 0
    v_mul_f32 v162, -0.5, v162
    v_mov_b32 v72, v162
    v_mov_b32 v73, v162
    v_mov_b32 v74, v162
    v_mov_b32 v75, v162
    v_mov_b32 v76, v162
    v_mov_b32 v77, v162
    v_mov_b32 v78, v162
    v_mov_b32 v79, v162
    v_mul_f32 v8, v36, v84
    v_mul_f32 v9, v37, v85
    v_mul_f32 v10, v38, v86
    v_mul_f32 v11, v39, v87
    v_mul_f32 v36, v36, v80
    v_mul_f32 v37, v37, v81
    v_mul_f32 v38, v38, v82
    v_mul_f32 v39, v39, v83
    v_fmac_f32 v36, v32, v84
    v_fmac_f32 v37, v33, v85
    v_fmac_f32 v38, v34, v86
    v_fmac_f32 v39, v35, v87
    v_fma_f32 v32, v32, v80, -v8
    v_fma_f32 v33, v33, v81, -v9
    v_fma_f32 v34, v34, v82, -v10
    v_fma_f32 v35, v35, v83, -v11
    v_cvt_pk_f16_f32 v16, v32, v36
    v_cvt_pk_f16_f32 v17, v33, v37
    v_cvt_pk_f16_f32 v18, v34, v38
    v_cvt_pk_f16_f32 v19, v35, v39
    v_mul_f32 v8, v44, v92
    v_mul_f32 v9, v45, v93
    v_mul_f32 v10, v46, v94
    v_mul_f32 v11, v47, v95
    v_mul_f32 v44, v44, v88
    v_mul_f32 v45, v45, v89
    v_mul_f32 v46, v46, v90
    v_mul_f32 v47, v47, v91
    v_fmac_f32 v44, v40, v92
    v_fmac_f32 v45, v41, v93
    v_fmac_f32 v46, v42, v94
    v_fmac_f32 v47, v43, v95
    v_fma_f32 v40, v40, v88, -v8
    v_fma_f32 v41, v41, v89, -v9
    v_fma_f32 v42, v42, v90, -v10
    v_fma_f32 v43, v43, v91, -v11
    v_cvt_pk_f16_f32 v24, v40, v44
    v_cvt_pk_f16_f32 v25, v41, v45
    v_cvt_pk_f16_f32 v26, v42, v46
    v_cvt_pk_f16_f32 v27, v43, v47
    v_mul_f32 v8, v52, v100
    v_mul_f32 v9, v53, v101
    v_mul_f32 v10, v54, v102
    v_mul_f32 v11, v55, v103
    v_mul_f32 v52, v52, v96
    v_mul_f32 v53, v53, v97
    v_mul_f32 v54, v54, v98
    v_mul_f32 v55, v55, v99
    v_fmac_f32 v52, v48, v100
    v_fmac_f32 v53, v49, v101
    v_fmac_f32 v54, v50, v102
    v_fmac_f32 v55, v51, v103
    v_fma_f32 v48, v48, v96, -v8
    v_fma_f32 v49, v49, v97, -v9
    v_fma_f32 v50, v50, v98, -v10
    v_fma_f32 v51, v51, v99, -v11
    v_cvt_pk_f16_f32 v20, v48, v52
    v_cvt_pk_f16_f32 v21, v49, v53
    v_cvt_pk_f16_f32 v22, v50, v54
    v_cvt_pk_f16_f32 v23, v51, v55
    v_mul_f32 v8, v60, v108
    v_mul_f32 v9, v61, v109
    v_mul_f32 v10, v62, v110
    v_mul_f32 v11, v63, v111
    v_mul_f32 v60, v60, v104
    v_mul_f32 v61, v61, v105
    v_mul_f32 v62, v62, v106
    v_mul_f32 v63, v63, v107
    v_fmac_f32 v60, v56, v108
    v_fmac_f32 v61, v57, v109
    v_fmac_f32 v62, v58, v110
    v_fmac_f32 v63, v59, v111
    v_fma_f32 v56, v56, v104, -v8
    v_fma_f32 v57, v57, v105, -v9
    v_fma_f32 v58, v58, v106, -v10
    v_fma_f32 v59, v59, v107, -v11
    v_cvt_pk_f16_f32 v28, v56, v60
    v_cvt_pk_f16_f32 v29, v57, v61
    v_cvt_pk_f16_f32 v30, v58, v62
    v_cvt_pk_f16_f32 v31, v59, v63
    v_mfma_f32_16x16x32_f16 v[64:67], v[112:115], v[16:19], 0
    v_mfma_f32_16x16x32_f16 v[68:71], v[120:123], v[16:19], 0
    v_mfma_f32_16x16x32_f16 v[72:75], v[112:115], v[24:27], v[72:75]
    v_mfma_f32_16x16x32_f16 v[76:79], v[120:123], v[24:27], v[76:79]
    v_mfma_f32_16x16x32_f16 v[64:67], v[116:119], v[20:23], v[64:67]
    v_mfma_f32_16x16x32_f16 v[68:71], v[124:127], v[20:23], v[68:71]
    v_mfma_f32_16x16x32_f16 v[72:75], v[116:119], v[28:31], v[72:75]
    v_mfma_f32_16x16x32_f16 v[76:79], v[124:127], v[28:31], v[76:79]
    s_mul_i32 s39, s94, 8
    s_and_b32 s38, s2, 7
    s_add_u32 s39, s39, s38
    s_mul_i32 s39, s39, 128
    s_add_u32 s39, s39, 0x488000
    v_mov_b32 v60, 0
    s_mov_b64 exec, 1
    buffer_atomic_or v60, v160, s[24:27], s39 offen sc0 sc1
    s_mov_b64 exec, -1
    v_bfe_u32 v54, v1, 0, 1
    v_add_u32 v54, -1, v54
    v_bfe_u32 v55, v1, 1, 1
    v_add_u32 v55, -1, v55
    v_bfe_u32 v56, v1, 2, 1
    v_add_u32 v56, -1, v56
    s_lshl_b32 s35, s94, 12
    s_add_u32 s35, s35, 0xed0000
    v_lshrrev_b32 v58, 3, v1
    v_lshlrev_b32 v58, 7, v58
    v_and_b32 v59, 28, v4
    v_add_u32 v58, v58, v59
    v_and_b32 v57, 28, v4
    s_lshl_b32 s36, s94, 5
    s_add_u32 s36, s36, 148480
    v_add_u32 v57, s36, v57
    v_fmac_f32 v128, s44, v64
    v_fmac_f32 v129, s44, v65
    v_fmac_f32 v130, s44, v66
    v_fmac_f32 v131, s44, v67
    v_fmac_f32 v132, s44, v68
    v_fmac_f32 v133, s44, v69
    v_fmac_f32 v134, s44, v70
    v_fmac_f32 v135, s44, v71
    v_fmac_f32 v136, s44, v72
    v_fmac_f32 v137, s44, v73
    v_fmac_f32 v138, s44, v74
    v_fmac_f32 v139, s44, v75
    v_fmac_f32 v140, s44, v76
    v_fmac_f32 v141, s44, v77
    v_fmac_f32 v142, s44, v78
    v_fmac_f32 v143, s44, v79
    v_add_f32 v150, 1.0, v148
    v_add_f32 v151, v149, v156
    v_fma_f32 v64, v128, v150, v151
    v_fma_f32 v65, v129, v150, v151
    v_fma_f32 v66, v130, v150, v151
    v_fma_f32 v67, v131, v150, v151
    v_fma_f32 v68, v132, v150, v151
    v_fma_f32 v69, v133, v150, v151
    v_fma_f32 v70, v134, v150, v151
    v_fma_f32 v71, v135, v150, v151
    v_fma_f32 v72, v136, v150, v151
    v_fma_f32 v73, v137, v150, v151
    v_fma_f32 v74, v138, v150, v151
    v_fma_f32 v75, v139, v150, v151
    v_fma_f32 v76, v140, v150, v151
    v_fma_f32 v77, v141, v150, v151
    v_fma_f32 v78, v142, v150, v151
    v_fma_f32 v79, v143, v150, v151
    v_cvt_pk_bf16_f32 v16, v64, v72
    v_cvt_pk_bf16_f32 v17, v65, v73
    v_cvt_pk_bf16_f32 v18, v66, v74
    v_cvt_pk_bf16_f32 v19, v67, v75
    v_cvt_pk_bf16_f32 v20, v68, v76
    v_cvt_pk_bf16_f32 v21, v69, v77
    v_cvt_pk_bf16_f32 v22, v70, v78
    v_cvt_pk_bf16_f32 v23, v71, v79
    s_setprio 2
    s_mov_b64 exec, 1
    s_waitcnt vmcnt(0)
    v_cmp_gt_u32 vcc, 32, v60
    s_nop 1
    s_cbranch_vccz m_p3_x
    s_mov_b64 exec, 1
m_p3:
    v_mov_b32 v60, 0
    buffer_atomic_or v60, v160, s[24:27], s39 offen sc0 sc1
    s_waitcnt vmcnt(0)
    v_cmp_gt_u32 vcc, 32, v60
    s_add_u32 s58, s58, 1
    s_cmp_gt_u32 s58, 2097152
    s_cbranch_scc1 m_p3_x
    s_cbranch_vccz m_p3_x
    s_sleep 2
    s_branch m_p3
m_p3_x:
    s_mov_b64 exec, -1
    buffer_load_dword v24, v58, s[24:27], s35 offen offset:0 sc1
    buffer_load_dword v25, v58, s[24:27], s35 offen offset:1024 sc1
    buffer_load_dword v26, v58, s[24:27], s35 offen offset:2048 sc1
    buffer_load_dword v27, v58, s[24:27], s35 offen offset:3072 sc1
    s_cmp_ge_u32 s94, 4
    s_cselect_b32 s38, s54, s50
    s_and_b32 s39, s2, 7
    s_mul_i32 s40, s39, 7
    s_sub_u32 s38, s38, s40
    s_lshl_b32 s38, s38, 5
    s_add_u32 s38, s38, s39
    s_lshl_b32 s38, s38, 7
    s_add_u32 s63, s38, 0xed0000
    v_and_b32 v154, 3, v1
    v_lshlrev_b32 v154, 10, v154
    s_setprio 1
    v_fma_f32 v80, v128, v148, v149
    v_fma_f32 v81, v129, v148, v149
    v_fma_f32 v82, v130, v148, v149
    v_fma_f32 v83, v131, v148, v149
    v_fma_f32 v84, v132, v148, v149
    v_fma_f32 v85, v133, v148, v149
    v_fma_f32 v86, v134, v148, v149
    v_fma_f32 v87, v135, v148, v149
    v_fma_f32 v88, v136, v148, v149
    v_fma_f32 v89, v137, v148, v149
    v_fma_f32 v90, v138, v148, v149
    v_fma_f32 v91, v139, v148, v149
    v_fma_f32 v92, v140, v148, v149
    v_fma_f32 v93, v141, v148, v149
    v_fma_f32 v94, v142, v148, v149
    v_fma_f32 v95, v143, v148, v149
    v_cvt_pk_bf16_f32 v8, v80, v88
    v_min_u32 v8, -2, v8
    v_cvt_pk_bf16_f32 v9, v81, v89
    v_min_u32 v9, -2, v9
    v_cvt_pk_bf16_f32 v10, v82, v90
    v_min_u32 v10, -2, v10
    v_cvt_pk_bf16_f32 v11, v83, v91
    v_min_u32 v11, -2, v11
    v_cvt_pk_bf16_f32 v12, v84, v92
    v_min_u32 v12, -2, v12
    v_cvt_pk_bf16_f32 v13, v85, v93
    v_min_u32 v13, -2, v13
    v_cvt_pk_bf16_f32 v14, v86, v94
    v_min_u32 v14, -2, v14
    v_cvt_pk_bf16_f32 v15, v87, v95
    v_min_u32 v15, -2, v15
    s_setprio 2
    s_branch k3_pk1
k3_pk:
    buffer_load_dword v24, v58, s[24:27], s35 offen offset:0 sc1
    buffer_load_dword v25, v58, s[24:27], s35 offen offset:1024 sc1
    buffer_load_dword v26, v58, s[24:27], s35 offen offset:2048 sc1
    buffer_load_dword v27, v58, s[24:27], s35 offen offset:3072 sc1
k3_pk1:
    s_waitcnt vmcnt(0)
    v_min3_u32 v28, v24, v25, v26
    v_min_u32 v28, v28, v27
    v_cmp_eq_u32 vcc, 0, v28
    s_add_u32 s58, s58, 1
    s_cmp_gt_u32 s58, 2097152
    s_cbranch_scc1 k3_pk_x
    s_cbranch_vccz k3_pk_x
    s_mov_b64 exec, vcc
    s_sleep 4
    s_branch k3_pk
k3_pk_x:
    s_mov_b64 exec, -1
    s_mov_b64 exec, 1
    ds_add_u32 v164, v165 offset:84
    s_mov_b64 exec, -1
    s_setprio 2
    v_max_u32_dpp v25, v25, v24 row_half_mirror row_mask:0xf bank_mask:0xf
    v_max_u32_dpp v27, v27, v26 row_half_mirror row_mask:0xf bank_mask:0xf
    s_nop 0
    v_max_u32_dpp v24, v25, v25 row_shl:4 row_mask:0xf bank_mask:0x5
    v_max_u32_dpp v26, v27, v27 row_shl:4 row_mask:0xf bank_mask:0x5
    s_nop 0
    v_min_u32_dpp v24, v25, v25 row_shr:4 row_mask:0xf bank_mask:0xa
    v_min_u32_dpp v26, v27, v27 row_shr:4 row_mask:0xf bank_mask:0xa
    s_nop 0
    v_mov_b32_dpp v28, v24 quad_perm:[2,3,0,1] row_mask:0xf bank_mask:0xf
    v_mov_b32_dpp v29, v26 quad_perm:[2,3,0,1] row_mask:0xf bank_mask:0xf
    v_med3_u32 v24, v24, v28, v55
    v_med3_u32 v26, v26, v29, v55
    s_nop 0
    v_mov_b32_dpp v28, v24 quad_perm:[1,0,3,2] row_mask:0xf bank_mask:0xf
    v_mov_b32_dpp v29, v26 quad_perm:[1,0,3,2] row_mask:0xf bank_mask:0xf
    v_med3_u32 v24, v24, v28, v54
    v_med3_u32 v26, v26, v29, v54
    s_nop 1
    v_max_u32_dpp v26, v26, v24 row_half_mirror row_mask:0xf bank_mask:0xf
    s_nop 1
    v_max_u32_dpp v24, v26, v26 row_shl:4 row_mask:0xf bank_mask:0x5
    s_nop 1
    v_min_u32_dpp v24, v26, v26 row_shr:4 row_mask:0xf bank_mask:0xa
    s_nop 1
    v_mov_b32_dpp v28, v24 quad_perm:[2,3,0,1] row_mask:0xf bank_mask:0xf
    v_med3_u32 v24, v24, v28, v55
    s_nop 1
    v_mov_b32_dpp v28, v24 quad_perm:[1,0,3,2] row_mask:0xf bank_mask:0xf
    v_med3_u32 v24, v24, v28, v54
    s_nop 1
    v_max_u32_dpp v25, v24, v24 row_mirror row_mask:0xf bank_mask:0xf
    s_nop 1
    v_max_u32_dpp v24, v25, v25 row_shl:4 row_mask:0xf bank_mask:0x5
    s_nop 1
    v_min_u32_dpp v24, v25, v25 row_shr:4 row_mask:0xf bank_mask:0xa
    s_nop 1
    v_mov_b32_dpp v28, v24 quad_perm:[2,3,0,1] row_mask:0xf bank_mask:0xf
    v_med3_u32 v24, v24, v28, v55
    s_nop 1
    v_mov_b32_dpp v28, v24 quad_perm:[1,0,3,2] row_mask:0xf bank_mask:0xf
    v_med3_u32 v24, v24, v28, v54
    v_mov_b32 v25, v24
    s_nop 1
    v_permlane16_swap_b32 v24, v25
    s_nop 1
    v_max_u32_dpp v25, v25, v24 row_half_mirror row_mask:0xf bank_mask:0xf
    s_nop 1
    v_max_u32_dpp v24, v25, v25 row_shl:4 row_mask:0xf bank_mask:0x5
    s_nop 1
    v_min_u32_dpp v24, v25, v25 row_shr:4 row_mask:0xf bank_mask:0xa
    s_nop 1
    v_mov_b32_dpp v28, v24 quad_perm:[2,3,0,1] row_mask:0xf bank_mask:0xf
    v_med3_u32 v24, v24, v28, v55
    s_nop 1
    v_mov_b32_dpp v28, v24 quad_perm:[1,0,3,2] row_mask:0xf bank_mask:0xf
    v_med3_u32 v24, v24, v28, v54
    v_mov_b32 v25, v24
    s_nop 1
    v_permlane32_swap_b32 v24, v25
    s_nop 1
    v_max_u32_dpp v25, v25, v24 row_half_mirror row_mask:0xf bank_mask:0xf
    s_nop 1
    v_max_u32_dpp v24, v25, v25 row_shl:4 row_mask:0xf bank_mask:0x5
    s_nop 1
    v_min_u32_dpp v24, v25, v25 row_shr:4 row_mask:0xf bank_mask:0xa
    s_nop 1
    v_mov_b32_dpp v28, v24 quad_perm:[2,3,0,1] row_mask:0xf bank_mask:0xf
    v_med3_u32 v24, v24, v28, v55
    s_nop 1
    v_mov_b32_dpp v28, v24 quad_perm:[1,0,3,2] row_mask:0xf bank_mask:0xf
    v_med3_u32 v24, v24, v28, v54
    ds_write_b32 v57, v24 offset:128
    s_mov_b64 exec, 1
    ds_add_u32 v164, v165 offset:80
    s_mov_b64 exec, -1
    s_setprio 1
m_b5:
    ds_read_b32 v28, v164 offset:80
    s_waitcnt lgkmcnt(0)
    v_cmp_gt_u32 vcc, 8, v28
    s_add_u32 s58, s58, 1
    s_cmp_gt_u32 s58, 2097152
    s_cbranch_scc1 m_b5_x
    s_cbranch_vccnz m_b5
m_b5_x:
    s_setprio 2
    ds_read_b32 v24, v153 offset:128
    s_waitcnt lgkmcnt(0)
    v_max_u32_dpp v25, v24, v24 row_mirror row_mask:0xf bank_mask:0xf
    s_nop 1
    v_max_u32_dpp v24, v25, v25 row_shl:4 row_mask:0xf bank_mask:0x5
    s_nop 1
    v_min_u32_dpp v24, v25, v25 row_shr:4 row_mask:0xf bank_mask:0xa
    s_nop 1
    v_mov_b32_dpp v28, v24 quad_perm:[2,3,0,1] row_mask:0xf bank_mask:0xf
    v_med3_u32 v24, v24, v28, v55
    s_nop 1
    v_mov_b32_dpp v28, v24 quad_perm:[1,0,3,2] row_mask:0xf bank_mask:0xf
    v_med3_u32 v24, v24, v28, v54
    v_mov_b32 v25, v24
    s_nop 1
    v_permlane16_swap_b32 v24, v25
    s_nop 1
    v_max_u32_dpp v25, v25, v24 row_half_mirror row_mask:0xf bank_mask:0xf
    s_nop 1
    v_max_u32_dpp v24, v25, v25 row_shl:4 row_mask:0xf bank_mask:0x5
    s_nop 1
    v_min_u32_dpp v24, v25, v25 row_shr:4 row_mask:0xf bank_mask:0xa
    s_nop 1
    v_mov_b32_dpp v28, v24 quad_perm:[2,3,0,1] row_mask:0xf bank_mask:0xf
    v_med3_u32 v24, v24, v28, v55
    s_nop 1
    v_mov_b32_dpp v28, v24 quad_perm:[1,0,3,2] row_mask:0xf bank_mask:0xf
    v_med3_u32 v24, v24, v28, v54
    v_mov_b32 v25, v24
    s_nop 1
    v_permlane32_swap_b32 v24, v25
    s_nop 1
    v_max_u32_dpp v24, v25, v24 row_half_mirror row_mask:0xf bank_mask:0xf
    v_cmp_eq_u32 vcc, v24, v152
    s_mov_b32 s62, 0
    s_cbranch_vccz k3_plain
    s_ff1_i32_b64 s36, vcc
    s_waitcnt vmcnt(0)
    s_lshl_b32 s38, s36, 11
    s_add_u32 s37, s38, 0xe20000
    buffer_store_dword v8, v4, s[24:27], s37 offen offset:0 sc1
    buffer_store_dword v9, v4, s[24:27], s37 offen offset:256 sc1
    buffer_store_dword v10, v4, s[24:27], s37 offen offset:512 sc1
    buffer_store_dword v11, v4, s[24:27], s37 offen offset:768 sc1
    buffer_store_dword v12, v4, s[24:27], s37 offen offset:1024 sc1
    buffer_store_dword v13, v4, s[24:27], s37 offen offset:1280 sc1
    buffer_store_dword v14, v4, s[24:27], s37 offen offset:1536 sc1
    buffer_store_dword v15, v4, s[24:27], s37 offen offset:1792 sc1
    s_add_u32 s38, s38, 0xe24000
    v_min_u32 v16, -2, v16
    buffer_store_dword v16, v4, s[24:27], s38 offen offset:0 sc1
    v_min_u32 v17, -2, v17
    buffer_store_dword v17, v4, s[24:27], s38 offen offset:256 sc1
    v_min_u32 v18, -2, v18
    buffer_store_dword v18, v4, s[24:27], s38 offen offset:512 sc1
    v_min_u32 v19, -2, v19
    buffer_store_dword v19, v4, s[24:27], s38 offen offset:768 sc1
    v_min_u32 v20, -2, v20
    buffer_store_dword v20, v4, s[24:27], s38 offen offset:1024 sc1
    v_min_u32 v21, -2, v21
    buffer_store_dword v21, v4, s[24:27], s38 offen offset:1280 sc1
    v_min_u32 v22, -2, v22
    buffer_store_dword v22, v4, s[24:27], s38 offen offset:1536 sc1
    v_min_u32 v23, -2, v23
    buffer_store_dword v23, v4, s[24:27], s38 offen offset:1792 sc1
    s_mov_b32 s62, 1
k3_plain:
k3_rowdone:
    s_cmp_ge_u32 s2, 224
    s_cbranch_scc1 k3_outs
    buffer_load_dword v155, v154, s[24:27], s63 offen offset:32 sc1
    v_lshrrev_b32 v29, 3, v2
    v_and_b32 v30, 1, v3
    v_lshl_or_b32 v29, v30, 1, v29
    s_and_b32 s36, s94, 3
    v_xor_b32 v29, s36, v29
    v_lshlrev_b32 v28, 10, v3
    v_lshrrev_b32 v30, 2, v2
    v_lshl_add_u32 v28, v30, 7, v28
    v_lshl_add_u32 v28, v29, 5, v28
    v_and_b32 v31, 3, v2
    v_lshl_add_u32 v28, v31, 3, v28
    s_lshr_b32 s37, s94, 2
    s_lshl_b32 s37, s37, 15
    s_add_u32 s37, s37, 50176
    v_add_u32 v28, s37, v28
    s_lshl_b32 s38, s94, 2
    s_add_u32 s38, s38, s51
    s_lshl_b32 s38, s38, 9
    s_add_u32 s38, s38, 0xe20000
    v_and_b32 v58, 0x1f0, v5
m_gu:
    ds_read_b32 v36, v164 offset:100
    s_waitcnt lgkmcnt(0)
    v_cmp_gt_u32 vcc, 4, v36
    s_add_u32 s58, s58, 1
    s_cmp_gt_u32 s58, 2097152
    s_cbranch_scc1 m_gu_x
    s_cbranch_vccnz m_gu
m_gu_x:
    ds_read_b64_tr_b16 v[96:97], v28 offset:0
    ds_read_b64_tr_b16 v[98:99], v28 offset:512
    ds_read_b64_tr_b16 v[100:101], v28 offset:4096
    ds_read_b64_tr_b16 v[102:103], v28 offset:4608
    ds_read_b64_tr_b16 v[104:105], v28 offset:8192
    ds_read_b64_tr_b16 v[106:107], v28 offset:8704
    ds_read_b64_tr_b16 v[108:109], v28 offset:12288
    ds_read_b64_tr_b16 v[110:111], v28 offset:12800
    ds_read_b64_tr_b16 v[112:113], v28 offset:16384
    ds_read_b64_tr_b16 v[114:115], v28 offset:16896
    ds_read_b64_tr_b16 v[116:117], v28 offset:20480
    ds_read_b64_tr_b16 v[118:119], v28 offset:20992
    ds_read_b64_tr_b16 v[120:121], v28 offset:24576
    ds_read_b64_tr_b16 v[122:123], v28 offset:25088
    ds_read_b64_tr_b16 v[124:125], v28 offset:28672
    ds_read_b64_tr_b16 v[126:127], v28 offset:29184
    s_mul_i32 s39, s94, 528
    s_add_u32 s39, s39, 148992
    v_add_u32 v59, s39, v58
    v_and_b32 v60, 7, v2
    v_mul_u32_u24 v60, 528, v60
    v_lshl_add_u32 v60, v3, 4, v60
    v_add_u32 v60, 148992, v60
    v_lshrrev_b32 v62, 1, v3
    s_lshl_b32 s40, s50, 14
    s_add_u32 s40, s40, 0xf00000
    s_cmp_ge_u32 s94, 4
    s_cselect_b32 s41, s54, s50
    s_lshl_b32 s41, s41, 14
    s_add_u32 s41, s41, 0xf00000
    s_lshl_b32 s42, s51, 12
    s_add_u32 s41, s41, s42
    s_lshl_b32 s42, s94, 9
    s_add_u32 s41, s41, s42
    s_lshl_b32 s42, s94, 8
    s_add_u32 s40, s40, s42
    buffer_load_dword v37, v4, s[24:27], s41 offen sc1
    buffer_load_dword v38, v4, s[24:27], s41 offen offset:256 sc1
k3_px:
    s_sleep 7
    buffer_load_dwordx4 v[32:35], v58, s[24:27], s38 offen sc1
    s_waitcnt vmcnt(0)
    v_max3_u32 v36, v32, v33, v34
    v_max_u32 v36, v36, v35
    v_cmp_eq_u32 vcc, -1, v36
    s_add_u32 s58, s58, 1
    s_cmp_gt_u32 s58, 2097152
    s_cbranch_scc1 k3_px_x
    s_cbranch_vccz k3_px_x
    s_mov_b64 exec, vcc
    s_branch k3_px
k3_px_x:
    s_mov_b64 exec, -1
    ds_write_b128 v59, v[32:35]
    s_waitcnt lgkmcnt(0)
    s_barrier
    ds_read_b128 v[64:67], v60 offset:0
    ds_read_b128 v[68:71], v60 offset:64
    ds_read_b128 v[72:75], v60 offset:128
    ds_read_b128 v[76:79], v60 offset:192
    ds_read_b128 v[80:83], v60 offset:256
    ds_read_b128 v[84:87], v60 offset:320
    ds_read_b128 v[88:91], v60 offset:384
    ds_read_b128 v[92:95], v60 offset:448
    s_waitcnt lgkmcnt(7)
    v_mfma_f32_16x16x32_bf16 v[32:35], v[64:67], v[96:99], 0
    s_waitcnt lgkmcnt(6)
    v_mfma_f32_16x16x32_bf16 v[32:35], v[68:71], v[100:103], v[32:35]
    s_waitcnt lgkmcnt(5)
    v_mfma_f32_16x16x32_bf16 v[32:35], v[72:75], v[104:107], v[32:35]
    s_waitcnt lgkmcnt(4)
    v_mfma_f32_16x16x32_bf16 v[32:35], v[76:79], v[108:111], v[32:35]
    s_waitcnt lgkmcnt(3)
    v_mfma_f32_16x16x32_bf16 v[32:35], v[80:83], v[112:115], v[32:35]
    s_waitcnt lgkmcnt(2)
    v_mfma_f32_16x16x32_bf16 v[32:35], v[84:87], v[116:119], v[32:35]
    s_waitcnt lgkmcnt(1)
    v_mfma_f32_16x16x32_bf16 v[32:35], v[88:91], v[120:123], v[32:35]
    s_waitcnt lgkmcnt(0)
    v_mfma_f32_16x16x32_bf16 v[32:35], v[92:95], v[124:127], v[32:35]
    v_and_b32 v29, 1, v3
    v_lshl_or_b32 v29, v29, 2, v30
    s_lshl_b32 s36, s94, 1
    v_xor_b32 v29, s36, v29
    v_lshlrev_b32 v28, 12, v3
    v_lshl_add_u32 v28, v30, 9, v28
    v_lshl_add_u32 v28, v31, 3, v28
    v_add_u32 v28, 115712, v28
    v_xor_b32 v30, 1, v29
    v_lshl_add_u32 v29, v29, 5, v28
    v_lshl_add_u32 v30, v30, 5, v28
    v_cmp_ne_u32 vcc, s56, v155
    v_cndmask_b32 v32, v34, v32, s[52:53]
    v_cndmask_b32 v33, v35, v33, s[52:53]
    v_min_u32 v32, -2, v32
    v_min_u32 v33, -2, v33
    s_cbranch_vccnz k3_gr
    buffer_store_dword v32, v4, s[24:27], s41 offen
    buffer_store_dword v33, v4, s[24:27], s41 offen offset:256
    s_branch k3_gs
k3_gr:
    buffer_store_dword v32, v4, s[24:27], s41 offen sc1
    buffer_store_dword v33, v4, s[24:27], s41 offen offset:256 sc1
k3_gs:
    ds_read_b64_tr_b16 v[128:129], v29 offset:0
    ds_read_b64_tr_b16 v[130:131], v29 offset:2048
    ds_read_b64_tr_b16 v[132:133], v29 offset:16384
    ds_read_b64_tr_b16 v[134:135], v29 offset:18432
    ds_read_b64_tr_b16 v[136:137], v30 offset:0
    ds_read_b64_tr_b16 v[138:139], v30 offset:2048
    ds_read_b64_tr_b16 v[140:141], v30 offset:16384
    ds_read_b64_tr_b16 v[142:143], v30 offset:18432
    s_and_b32 s39, s94, 1
    s_lshl_b32 s39, s39, 7
    s_lshr_b32 s42, s94, 1
    s_lshl_b32 s42, s42, 5
    s_add_u32 s39, s39, s42
    s_add_u32 s39, s39, 153344
    v_and_b32 v59, 1, v3
    v_lshlrev_b32 v59, 9, v59
    v_lshl_add_u32 v59, v62, 8, v59
    v_lshl_add_u32 v59, v2, 1, v59
    v_add_u32 v59, s39, v59
    v_and_b32 v60, 7, v2
    v_lshlrev_b32 v60, 7, v60
    v_lshl_add_u32 v60, v3, 4, v60
    v_add_u32 v60, 153344, v60
    v_and_b32 v61, 1, v3
    s_mov_b32 s39, 917504
    v_mul_lo_u32 v61, v61, s39
    v_lshl_add_u32 v61, v62, 6, v61
    v_lshl_add_u32 v61, v2, 2, v61
    s_lshl_b32 s41, s55, 3
    s_add_u32 s41, s41, s94
    s_mul_i32 s41, s41, 7168
    s_lshl_b32 s42, s50, 7
    s_add_u32 s41, s41, s42
    s_add_u32 s41, s41, 0x1200000
    s_add_u32 s42, s40, 4096
    s_add_u32 s43, s40, 8192
    s_add_u32 s46, s40, 12288
k3_pg:
    s_sleep 2
    buffer_load_dword v64, v4, s[24:27], s40 offen sc1
    buffer_load_dword v65, v4, s[24:27], s40 offen offset:2048 sc1
    buffer_load_dword v66, v4, s[24:27], s42 offen sc1
    buffer_load_dword v67, v4, s[24:27], s42 offen offset:2048 sc1
    buffer_load_dword v68, v4, s[24:27], s43 offen sc1
    buffer_load_dword v69, v4, s[24:27], s43 offen offset:2048 sc1
    buffer_load_dword v70, v4, s[24:27], s46 offen sc1
    buffer_load_dword v71, v4, s[24:27], s46 offen offset:2048 sc1
    s_waitcnt vmcnt(0)
    v_max3_u32 v72, v64, v65, v66
    v_max3_u32 v73, v67, v68, v69
    v_max3_u32 v72, v72, v70, v71
    v_max_u32 v72, v72, v73
    v_cmp_eq_u32 vcc, -1, v72
    s_add_u32 s58, s58, 1
    s_cmp_gt_u32 s58, 2097152
    s_cbranch_scc1 k3_pg_x
    s_cbranch_vccz k3_pg_x
    s_mov_b64 exec, vcc
    s_branch k3_pg
k3_pg_x:
    s_mov_b64 exec, -1
    v_add_f32 v64, v64, v66
    v_add_f32 v65, v65, v67
    v_add_f32 v68, v68, v70
    v_add_f32 v69, v69, v71
    v_add_f32 v64, v64, v68
    v_add_f32 v65, v65, v69
    v_cvt_pk_bf16_f32 v64, 0, v64
    v_cvt_pk_bf16_f32 v65, 0, v65
    v_mul_f32 v66, 0xbfb8aa3b, v64
    v_exp_f32 v66, v66
    s_nop 0
    v_add_f32 v66, 1.0, v66
    v_rcp_f32 v66, v66
    s_nop 0
    v_mul_f32 v64, v64, v66
    v_cvt_pk_bf16_f32 v64, 0, v64
    v_mul_f32 v64, v64, v65
    v_cvt_pk_bf16_f32 v64, v64, v64
    ds_write_b16 v59, v64
    s_waitcnt lgkmcnt(0)
    s_barrier
    ds_read_b128 v[64:67], v60
    ds_read_b128 v[68:71], v60 offset:64
    s_waitcnt lgkmcnt(0)
    v_mfma_f32_16x16x32_bf16 v[32:35], v[64:67], v[128:131], 0
    v_mfma_f32_16x16x32_bf16 v[36:39], v[64:67], v[136:139], 0
    v_mfma_f32_16x16x32_bf16 v[32:35], v[68:71], v[132:135], v[32:35]
    v_mfma_f32_16x16x32_bf16 v[36:39], v[68:71], v[140:143], v[36:39]
    s_nop 7
    v_cndmask_b32 v32, v36, v32, s[52:53]
    v_cndmask_b32 v33, v37, v33, s[52:53]
    v_cndmask_b32 v34, v38, v34, s[52:53]
    v_cndmask_b32 v35, v39, v35, s[52:53]
    v_min_u32 v32, -2, v32
    buffer_store_dword v32, v61, s[24:27], s41 offen sc1
    s_add_u32 s41, s41, 229376
    v_min_u32 v33, -2, v33
    buffer_store_dword v33, v61, s[24:27], s41 offen sc1
    s_add_u32 s41, s41, 229376
    v_min_u32 v34, -2, v34
    buffer_store_dword v34, v61, s[24:27], s41 offen sc1
    s_add_u32 s41, s41, 229376
    v_min_u32 v35, -2, v35
    buffer_store_dword v35, v61, s[24:27], s41 offen sc1
    s_mul_i32 s57, s94, 224
    s_add_u32 s57, s57, s2
    s_cmp_ge_u32 s57, 256
    s_cbranch_scc1 k3_outs
    s_lshr_b32 s36, s57, 5
    v_readlane_b32 s38, v24, s36
    s_mul_i32 s40, s57, 7168
    s_add_u32 s40, s40, 0x1200000
    s_add_u32 s41, s40, 4096
    v_and_b32 v28, 7, v1
    v_lshlrev_b32 v28, 2, v28
    v_add_u32 v28, v28, v3
    v_lshlrev_b32 v28, 1, v28
    s_and_b32 s43, s38, 0x7ff
    s_sub_u32 s43, 0x7ff, s43
    s_lshl_b32 s43, s43, 11
    s_and_b32 s44, s57, 31
    s_lshl_b32 s44, s44, 6
    s_add_u32 s43, s43, s44
    s_ashr_i32 s44, s38, 31
    s_not_b32 s44, s44
    s_or_b32 s44, s44, 0x80000000
    s_xor_b32 s45, s38, s44
    v_cvt_pk_bf16_f32 v30, 0, s45
    v_mul_f32 v30, 0xbfb8aa3b, v30
    v_exp_f32 v30, v30
    s_nop 0
    v_add_f32 v30, 1.0, v30
    v_rcp_f32 v30, v30
    s_nop 0
    v_cvt_pk_bf16_f32 v30, 0, v30
    s_lshl_b32 s42, s57, 6
    s_add_u32 s42, s42, 0xe24000
    v_and_b32 v29, 60, v28
    v_and_b32 v31, 1, v3
    v_lshlrev_b32 v31, 4, v31
k3_py:
    s_sleep 12
    buffer_load_dwordx4 v[64:67], v5, s[24:27], s40 offen offset:0 sc1
    buffer_load_dwordx4 v[68:71], v5, s[24:27], s40 offen offset:1024 sc1
    buffer_load_dwordx4 v[72:75], v5, s[24:27], s40 offen offset:2048 sc1
    buffer_load_dwordx4 v[76:79], v5, s[24:27], s40 offen offset:3072 sc1
    buffer_load_dwordx4 v[80:83], v5, s[24:27], s41 offen offset:0 sc1
    buffer_load_dwordx4 v[84:87], v5, s[24:27], s41 offen offset:1024 sc1
    buffer_load_dwordx4 v[88:91], v5, s[24:27], s41 offen offset:2048 sc1
    buffer_load_dword v92, v29, s[24:27], s42 offen sc1
    ds_write_b32 v164, v165 offset:120
    s_waitcnt vmcnt(0)
    v_max3_u32 v93, v64, v65, v92
    v_max3_u32 v94, v66, v67, v93
    v_max3_u32 v93, v68, v69, v93
    v_max3_u32 v94, v70, v71, v94
    v_max3_u32 v93, v72, v73, v93
    v_max3_u32 v94, v74, v75, v94
    v_max3_u32 v93, v76, v77, v93
    v_max3_u32 v94, v78, v79, v94
    v_max3_u32 v93, v80, v81, v93
    v_max3_u32 v94, v82, v83, v94
    v_max3_u32 v93, v84, v85, v93
    v_max3_u32 v94, v86, v87, v94
    v_max3_u32 v93, v88, v89, v93
    v_max3_u32 v94, v90, v91, v94
    v_max_u32 v93, v93, v94
    v_cmp_eq_u32 vcc, -1, v93
    s_add_u32 s58, s58, 1
    s_cmp_gt_u32 s58, 2097152
    s_cbranch_scc1 k3_py_x
    s_cbranch_vccz k3_py_x
    s_mov_b64 exec, vcc
    s_branch k3_py
k3_py_x:
    s_mov_b64 exec, -1
    s_cmp_eq_u32 s62, 1
    s_cbranch_scc1 k3_o1
    buffer_store_dword v16, v4, s[20:23], s31 offen offset:0 sc1
    buffer_store_dword v17, v4, s[20:23], s31 offen offset:256 sc1
    buffer_store_dword v18, v4, s[20:23], s31 offen offset:512 sc1
    buffer_store_dword v19, v4, s[20:23], s31 offen offset:768 sc1
    buffer_store_dword v20, v4, s[20:23], s31 offen offset:1024 sc1
    buffer_store_dword v21, v4, s[20:23], s31 offen offset:1280 sc1
    buffer_store_dword v22, v4, s[20:23], s31 offen offset:1536 sc1
    buffer_store_dword v23, v4, s[20:23], s31 offen offset:1792 sc1
k3_o1:
    v_add_f32 v68, v68, v72
    v_add_f32 v69, v69, v73
    v_add_f32 v70, v70, v74
    v_add_f32 v71, v71, v75
    v_add_f32 v76, v76, v80
    v_add_f32 v77, v77, v81
    v_add_f32 v78, v78, v82
    v_add_f32 v79, v79, v83
    v_add_f32 v84, v84, v88
    v_add_f32 v85, v85, v89
    v_add_f32 v86, v86, v90
    v_add_f32 v87, v87, v91
    v_add_f32 v64, v64, v68
    v_add_f32 v65, v65, v69
    v_add_f32 v66, v66, v70
    v_add_f32 v67, v67, v71
    v_add_f32 v76, v76, v84
    v_add_f32 v77, v77, v85
    v_add_f32 v78, v78, v86
    v_add_f32 v79, v79, v87
    v_add_f32 v64, v64, v76
    v_add_f32 v65, v65, v77
    v_add_f32 v66, v66, v78
    v_add_f32 v67, v67, v79
    s_nop 0
    v_permlane32_swap_b32 v64, v66
    v_permlane32_swap_b32 v65, v67
    v_add_f32 v64, v64, v66
    v_add_f32 v65, v65, v67
    s_nop 1
    v_permlane16_swap_b32 v64, v65
    v_add_f32 v64, v64, v65
    s_nop 1
    v_add_f32_dpp v64, v64, v64 row_ror:8 row_mask:0xf bank_mask:0xf
    v_cvt_pk_bf16_f32 v64, 0, v64
    v_mul_f32 v64, v64, v30
    v_cvt_pk_bf16_f32 v64, 0, v64
    v_lshrrev_b32 v92, v31, v92
    v_lshlrev_b32 v92, 16, v92
    v_add_f32 v64, v64, v92
    v_cvt_pk_bf16_f32 v64, v64, v64
    buffer_store_short v64, v28, s[20:23], s43 offen
    s_branch k3_fin
k3_outs:
    s_cmp_eq_u32 s62, 1
    s_cbranch_scc1 k3_fin
    s_cmp_ge_u32 s2, 224
    s_cbranch_scc1 m_fin_x
m_fin:
    ds_read_b32 v28, v164 offset:120
    s_waitcnt lgkmcnt(0)
    v_cmp_gt_u32 vcc, 1, v28
    s_add_u32 s58, s58, 1
    s_cmp_gt_u32 s58, 2097152
    s_cbranch_scc1 m_fin_x
    s_cbranch_vccz m_fin_x
    s_sleep 1
    s_branch m_fin
m_fin_x:
    buffer_store_dword v16, v4, s[20:23], s31 offen offset:0 sc1
    buffer_store_dword v17, v4, s[20:23], s31 offen offset:256 sc1
    buffer_store_dword v18, v4, s[20:23], s31 offen offset:512 sc1
    buffer_store_dword v19, v4, s[20:23], s31 offen offset:768 sc1
    buffer_store_dword v20, v4, s[20:23], s31 offen offset:1024 sc1
    buffer_store_dword v21, v4, s[20:23], s31 offen offset:1280 sc1
    buffer_store_dword v22, v4, s[20:23], s31 offen offset:1536 sc1
    buffer_store_dword v23, v4, s[20:23], s31 offen offset:1792 sc1
    s_branch k3_fin
m_helper2:
    v_and_b32 v2, 15, v1
    v_lshrrev_b32 v3, 4, v1
    v_mov_b32 v164, 148480
    v_mov_b32 v165, 1
    s_mov_b32 s26, 0x1400000
    s_mov_b32 s27, 0x00020000
    s_mov_b32 s58, 0
    s_and_b32 s50, s2, 7
    s_mul_i32 s50, s50, 7
    s_lshr_b32 s51, s2, 5
    s_add_u32 s54, s51, 3
    s_cmp_ge_u32 s54, 7
    s_cselect_b32 s55, 7, 0
    s_sub_u32 s54, s54, s55
    s_add_u32 s54, s54, s50
    s_add_u32 s50, s50, s51
    s_bfe_u32 s51, s2, 0x20003
    s_mov_b32 s55, s51
    v_mov_b32 v8, 0
    s_mov_b32 s46, 0x201000
    s_mov_b32 s47, 0x00020000
    v_lshrrev_b32 v14, 5, v1
    s_lshl_b32 s38, s59, 12
    s_mov_b32 s44, s6
    s_mov_b32 s45, s7
    s_mov_b32 s40, s8
    s_mov_b32 s41, s9
    s_waitcnt lgkmcnt(0)
    s_mov_b32 s24, s10
    s_mov_b32 s25, s11
    s_mov_b32 s20, s74
    s_mov_b32 s21, s75
    s_mov_b32 s22, 0x100
    s_mov_b32 s23, 0x00020000
m_ha1:
    s_cmp_lg_u32 s59, 3
    s_cbranch_scc1 m_hr0
    global_load_dword v128, v4, s[64:65] offset:0
    global_load_dword v129, v4, s[64:65] offset:256
    global_load_dword v130, v4, s[64:65] offset:512
    global_load_dword v131, v4, s[64:65] offset:768
    global_load_dword v132, v4, s[64:65] offset:1024
    global_load_dword v133, v4, s[64:65] offset:1280
    global_load_dword v134, v4, s[64:65] offset:1536
    global_load_dword v135, v4, s[64:65] offset:1792
    ds_read_b128 v[64:67], v5 offset:0
    ds_read_b128 v[68:71], v5 offset:1024
    ds_read_b128 v[72:75], v5 offset:2048
    ds_read_b128 v[76:79], v5 offset:3072
    ds_read_b128 v[80:83], v5 offset:4096
    ds_read_b128 v[84:87], v5 offset:5120
    ds_read_b128 v[88:91], v5 offset:6144
    ds_read_b128 v[92:95], v5 offset:7168
    ds_read_b128 v[96:99], v5 offset:8192
    ds_read_b128 v[100:103], v5 offset:9216
    ds_read_b128 v[104:107], v5 offset:10240
    ds_read_b128 v[108:111], v5 offset:11264
    ds_read_b128 v[112:115], v5 offset:12288
    ds_read_b128 v[116:119], v5 offset:13312
    ds_read_b128 v[120:123], v5 offset:14336
    ds_read_b128 v[124:127], v5 offset:15360
m_hr0:
    s_mov_b32 s12, s66
    s_mov_b32 s13, s67
    s_mov_b32 s14, 0x700000
    s_mov_b32 s15, 0x00020000
    s_mov_b32 s16, s68
    s_mov_b32 s17, s69
    s_mov_b32 s18, 0x700000
    s_mov_b32 s19, 0x00020000
    s_lshl_b32 s60, s2, 1
    s_add_u32 s60, s60, s59
    s_mul_i32 s60, s60, 128
    s_add_u32 s60, s60, 0x480000
    s_cmp_lt_u32 s59, 2
    s_cselect_b64 exec, 0xffff, 0
    s_cbranch_scc0 m_ha2
    buffer_store_dword v8, v4, s[24:27], s60 offen sc1
m_ha2:
    s_mov_b64 exec, -1
    s_getpc_b64 s[28:29]
    s_add_u32 s28, s28, tab3@rel32@lo+4
    s_addc_u32 s29, s29, tab3@rel32@hi+12
    s_add_u32 s28, s28, s38
    s_addc_u32 s29, s29, 0
    s_add_u32 m0, s38, 33792
    s_nop 0
    global_load_lds_dwordx4 v5, s[28:29] offset:0
    global_load_lds_dwordx4 v5, s[28:29] offset:1024
    global_load_lds_dwordx4 v5, s[28:29] offset:2048
    global_load_lds_dwordx4 v5, s[28:29] offset:3072
    s_bitcmp1_b32 s59, 0
    s_cselect_b32 s44, s40, s44
    s_cselect_b32 s45, s41, s45
    s_cselect_b32 s60, 8192, 0
    s_and_b32 s42, s2, 3
    s_bfe_u32 s43, s2, 0x10003
    s_lshl_b32 s41, s42, 1
    s_add_u32 s41, s41, s43
    s_lshr_b32 s35, s2, 4
    s_and_b32 s36, s2, 4
    s_lshl_b32 s36, s36, 2
    s_add_u32 s35, s35, s36
    v_lshrrev_b32 v11, 1, v1
    v_mul_u32_u24 v11, 8208, v11
    v_and_b32 v12, 16, v5
    v_add_u32 v11, v11, v12
    s_mul_i32 s32, s41, 1026
    s_lshl_b32 s33, s35, 5
    s_add_u32 s32, s32, s33
    s_add_u32 s32, s32, 2
    s_lshr_b32 s34, s59, 1
    s_mul_i32 s33, s34, 262656
    s_add_u32 s32, s32, s33
    s_lshl_b32 s34, s34, 10
    s_add_u32 s60, s60, s34
    s_add_u32 s63, s60, 99328
    v_mov_b32 v8, 0
    v_lshrrev_b32 v14, 5, v1
    v_and_b32 v12, 1, v3
    v_and_b32 v13, 1, v7
    v_lshl_or_b32 v12, v13, 1, v12
    v_lshlrev_b32 v12, 5, v12
    v_and_b32 v15, 0x70, v5
    v_xor_b32 v12, v12, v15
    v_lshrrev_b32 v15, 3, v1
    v_mul_u32_u24 v15, 7168, v15
    v_add_u32 v12, v12, v15
    v_lshl_or_b32 v13, v13, 1, v14
    v_lshlrev_b32 v13, 5, v13
    v_and_b32 v15, 0x1f0, v5
    v_xor_b32 v13, v13, v15
    v_lshl_add_u32 v13, v14, 11, v13
    v_xor_b32 v14, 128, v13
    v_mov_b32 v24, -1
    v_mov_b32 v25, -1
    v_mov_b32 v26, -1
    v_mov_b32 v27, -1
    s_mul_i32 s36, s51, 1835008
    s_mul_i32 s37, s59, 57344
    s_add_u32 s36, s36, s37
    s_lshl_b32 s37, s54, 7
    s_add_u32 s56, s36, s37
    s_lshl_b32 s37, s50, 7
    s_add_u32 s36, s36, s37
    s_lshl_b32 s37, s50, 17
    s_add_u32 s37, s37, s38
    s_lshl_b32 s39, s55, 9
    s_add_u32 s37, s37, s39
    s_lshl_b32 s39, s59, 10
    s_waitcnt vmcnt(0)
    s_cmp_lg_u32 s59, 0
    s_cbranch_scc1 m_hn0
    s_mov_b64 exec, 1
    buffer_load_dwordx2 v[18:19], v8, s[20:23], 0 offen sc1
    s_mov_b64 exec, -1
m_hn0:
    v_and_b32 v32, 0x7fff7fff, v32
    v_and_b32 v33, 0x7fff7fff, v33
    v_and_b32 v34, 0x7fff7fff, v34
    v_and_b32 v35, 0x7fff7fff, v35
    v_and_b32 v36, 0x7fff7fff, v36
    v_and_b32 v37, 0x7fff7fff, v37
    v_and_b32 v38, 0x7fff7fff, v38
    v_and_b32 v39, 0x7fff7fff, v39
    v_and_b32 v40, 0x7fff7fff, v40
    v_and_b32 v41, 0x7fff7fff, v41
    v_and_b32 v42, 0x7fff7fff, v42
    v_and_b32 v43, 0x7fff7fff, v43
    v_and_b32 v44, 0x7fff7fff, v44
    v_and_b32 v45, 0x7fff7fff, v45
    v_and_b32 v46, 0x7fff7fff, v46
    v_and_b32 v47, 0x7fff7fff, v47
    v_pk_max_u16 v32, v32, v40
    v_pk_max_u16 v33, v33, v41
    v_pk_max_u16 v34, v34, v42
    v_pk_max_u16 v35, v35, v43
    v_pk_max_u16 v36, v36, v44
    v_pk_max_u16 v37, v37, v45
    v_pk_max_u16 v38, v38, v46
    v_pk_max_u16 v39, v39, v47
    v_pk_max_u16 v32, v32, v36
    v_pk_max_u16 v33, v33, v37
    v_pk_max_u16 v34, v34, v38
    v_pk_max_u16 v35, v35, v39
    v_pk_max_u16 v32, v32, v34
    v_pk_max_u16 v33, v33, v35
    v_pk_max_u16 v32, v32, v33
    v_lshrrev_b32 v33, 16, v32
    v_and_b32 v32, 0xffff, v32
    v_max_u32 v32, v32, v33
    s_nop 1
    v_max_u32_dpp v32, v32, v32 quad_perm:[1,0,3,2] row_mask:0xf bank_mask:0xf
    s_nop 1
    v_max_u32_dpp v32, v32, v32 quad_perm:[2,3,0,1] row_mask:0xf bank_mask:0xf
    s_nop 1
    v_max_u32_dpp v32, v32, v32 row_half_mirror row_mask:0xf bank_mask:0xf
    s_nop 1
    v_max_u32_dpp v32, v32, v32 row_mirror row_mask:0xf bank_mask:0xf
    s_mov_b32 exec_lo, 0x00010001
    s_mov_b32 exec_hi, 0x00010001
    ds_max_u32 v164, v32 offset:68
    s_mov_b64 exec, 1
    ds_add_u32 v164, v165 offset:84
    s_cmp_lg_u32 s59, 0
    s_cbranch_scc1 m_hq0
    s_waitcnt vmcnt(0)
    v_cmp_eq_u32 vcc, 0, v19
    s_nop 1
    s_cbranch_vccz m_hm_x
m_hm:
    buffer_load_dwordx2 v[18:19], v8, s[20:23], 0 offen sc1
    s_waitcnt vmcnt(0)
    v_cmp_eq_u32 vcc, 0, v19
    s_add_u32 s58, s58, 1
    s_cmp_gt_u32 s58, 2097152
    s_cbranch_scc1 m_hm_x
    s_cbranch_vccz m_hm_x
    s_sleep 16
    s_branch m_hm
m_hm_x:
    ds_write_b64 v164, v[18:19] offset:104
m_hq0:
    s_mov_b64 exec, 1
    ds_add_u32 v164, v165 offset:88
    s_mov_b64 exec, -1
m_hq:
    s_mov_b64 exec, -1
    s_add_u32 m0, s63, 0
    s_nop 0
    buffer_load_dwordx4 v11, s[44:47], s32 offen lds
    s_add_u32 s32, s32, 525312
    s_add_u32 m0, s63, 2048
    s_nop 0
    buffer_load_dwordx4 v11, s[44:47], s32 offen lds
    s_add_u32 s32, s32, 525312
    s_add_u32 m0, s63, 4096
    s_nop 0
    buffer_load_dwordx4 v11, s[44:47], s32 offen lds
    s_add_u32 s32, s32, 525312
    s_add_u32 m0, s63, 6144
    s_nop 0
    buffer_load_dwordx4 v11, s[44:47], s32 offen lds
    s_waitcnt vmcnt(0)
    s_mov_b64 exec, 1
    ds_add_u32 v164, v165 offset:92
    s_mov_b64 exec, -1
    s_lshl_b32 s34, s2, 7
    s_mov_b64 exec, -1
    s_mov_b32 s20, s70
    s_mov_b32 s21, s71
    s_mov_b32 s22, 0x700000
    s_mov_b32 s23, 0x00020000
    s_mul_i32 s35, s2, 7168
    s_lshl_b32 s33, s59, 11
    s_add_u32 s35, s35, s33
    s_add_u32 s35, s35, 0x1200000
    s_lshl_b32 s33, s2, 12
    s_add_u32 s33, s33, s39
    s_add_u32 s33, s33, 0xf00000
    s_add_u32 s61, s34, 0xe20000
    s_lshl_b32 s34, s2, 7
    s_add_u32 s34, s34, 0xed0000
    s_mov_b32 s62, s33
m_h1:
    ds_read_b32 v9, v164 offset:72
    s_waitcnt lgkmcnt(0)
    v_cmp_gt_u32 vcc, 8, v9
    s_add_u32 s58, s58, 1
    s_cmp_gt_u32 s58, 2097152
    s_cbranch_scc1 m_h1_x
    s_cbranch_vccz m_h1_x
    s_sleep 1
    s_branch m_h1
m_h1_x:
    s_cmp_ge_u32 s2, 224
    s_cbranch_scc1 m_hs1
    s_add_u32 s33, s37, 0
    s_add_u32 m0, s39, 115712
    s_nop 0
    buffer_load_dwordx4 v13, s[20:23], s33 offen nt lds
    s_add_u32 s33, s37, 16384
    s_add_u32 m0, s39, 119808
    s_nop 0
    buffer_load_dwordx4 v14, s[20:23], s33 offen nt lds
    s_add_u32 s33, s37, 32768
    s_add_u32 m0, s39, 123904
    s_nop 0
    buffer_load_dwordx4 v13, s[20:23], s33 offen nt lds
    s_add_u32 s33, s37, 49152
    s_add_u32 m0, s39, 128000
    s_nop 0
    buffer_load_dwordx4 v14, s[20:23], s33 offen nt lds
    s_add_u32 s33, s37, 65536
    s_add_u32 m0, s39, 132096
    s_nop 0
    buffer_load_dwordx4 v13, s[20:23], s33 offen nt lds
    s_add_u32 s33, s37, 81920
    s_add_u32 m0, s39, 136192
    s_nop 0
    buffer_load_dwordx4 v14, s[20:23], s33 offen nt lds
m_hs1:
    s_cmp_lg_u32 s59, 3
    s_cbranch_scc1 m_hr2
    s_mov_b64 s[96:97], s[36:37]
    s_mov_b64 s[98:99], s[38:39]
    s_mov_b32 s100, s62
    s_mov_b32 s62, 0xda24260
    s_mov_b64 s[46:47], 1
    v_lshlrev_b32 v166, 3, v2
    v_add_u32 v166, 148992, v166
    v_lshl_add_u32 v146, v3, 10, v166
    s_setprio 0
    s_mov_b32 s101, 1
    s_branch m_row1
m_rowh:
    ds_write_b32 v164, v161 offset:116
    s_mov_b64 exec, 1
    ds_add_u32 v164, v165 offset:112
    s_mov_b64 exec, -1
    s_mov_b64 s[36:37], s[96:97]
    s_mov_b64 s[38:39], s[98:99]
    s_mov_b32 s62, s100
    v_mov_b32 v8, 0
    v_lshrrev_b32 v14, 5, v1
    v_and_b32 v12, 1, v3
    v_and_b32 v13, 1, v7
    v_lshl_or_b32 v12, v13, 1, v12
    v_lshlrev_b32 v12, 5, v12
    v_and_b32 v15, 0x70, v5
    v_xor_b32 v12, v12, v15
    v_lshrrev_b32 v15, 3, v1
    v_mul_u32_u24 v15, 7168, v15
    v_add_u32 v12, v12, v15
    v_lshl_or_b32 v13, v13, 1, v14
    v_lshlrev_b32 v13, 5, v13
    v_and_b32 v15, 0x1f0, v5
    v_xor_b32 v13, v13, v15
    v_lshl_add_u32 v13, v14, 11, v13
    v_xor_b32 v14, 128, v13
    v_mov_b32 v24, -1
    v_mov_b32 v25, -1
    v_mov_b32 v26, -1
    v_mov_b32 v27, -1
    s_setprio 3
m_hr2:
m_h2:
    ds_read_b32 v9, v164 offset:56
    s_waitcnt lgkmcnt(0)
    v_cmp_gt_u32 vcc, 8, v9
    s_add_u32 s58, s58, 1
    s_cmp_gt_u32 s58, 2097152
    s_cbranch_scc1 m_h2_x
    s_cbranch_vccz m_h2_x
    s_sleep 2
    s_branch m_h2
m_h2_x:
    buffer_store_dwordx4 v[24:27], v5, s[24:27], s35 offen sc1
    buffer_store_dwordx4 v[24:27], v5, s[24:27], s62 offen sc1
    s_add_u32 s35, s35, 1024
    s_cmp_eq_u32 s59, 3
    s_cselect_b32 s35, s61, s35
    s_cselect_b64 exec, 0xff, -1
    buffer_store_dwordx4 v[24:27], v5, s[24:27], s35 offen sc1
    s_mov_b64 exec, -1
    s_mov_b64 exec, 0x1ff
    buffer_store_dword v8, v4, s[24:27], s34 offen sc1
    s_mov_b64 exec, -1
    s_cmp_ge_u32 s2, 224
    s_cbranch_scc1 m_hs2
    s_add_u32 s33, s36, 0
    s_add_u32 m0, s39, 50176
    s_nop 0
    buffer_load_dwordx4 v12, s[12:15], s33 offen nt lds
    s_add_u32 s33, s56, 0
    s_add_u32 m0, s39, 82944
    s_nop 0
    buffer_load_dwordx4 v12, s[16:19], s33 offen nt lds
    s_add_u32 s33, s36, 229376
    s_add_u32 m0, s39, 54272
    s_nop 0
    buffer_load_dwordx4 v12, s[12:15], s33 offen nt lds
m_hs2:
    s_waitcnt vmcnt(0)
    s_mov_b64 exec, 1
    ds_add_u32 v164, v165 offset:60
    s_mov_b64 exec, -1
    s_cmp_ge_u32 s2, 224
    s_cbranch_scc1 k3_fin
m_h4:
    ds_read_b32 v9, v164 offset:76
    s_waitcnt lgkmcnt(0)
    v_cmp_gt_u32 vcc, 8, v9
    s_add_u32 s58, s58, 1
    s_cmp_gt_u32 s58, 2097152
    s_cbranch_scc1 m_h4_x
    s_cbranch_vccz m_h4_x
    s_sleep 1
    s_branch m_h4
m_h4_x:
    s_add_u32 s33, s56, 229376
    s_add_u32 m0, s39, 87040
    s_nop 0
    buffer_load_dwordx4 v12, s[16:19], s33 offen nt lds
    s_add_u32 s33, s36, 458752
    s_add_u32 m0, s39, 58368
    s_nop 0
    buffer_load_dwordx4 v12, s[12:15], s33 offen nt lds
    s_add_u32 s33, s56, 458752
    s_add_u32 m0, s39, 91136
    s_nop 0
    buffer_load_dwordx4 v12, s[16:19], s33 offen nt lds
    s_add_u32 s33, s36, 688128
    s_add_u32 m0, s39, 62464
    s_nop 0
    buffer_load_dwordx4 v12, s[12:15], s33 offen nt lds
m_h3:
    ds_read_b32 v9, v164 offset:52
    s_waitcnt lgkmcnt(0)
    v_cmp_gt_u32 vcc, 8, v9
    s_add_u32 s58, s58, 1
    s_cmp_gt_u32 s58, 2097152
    s_cbranch_scc1 m_h3_x
    s_cbranch_vccz m_h3_x
    s_sleep 1
    s_branch m_h3
m_h3_x:
    s_add_u32 s33, s56, 688128
    s_add_u32 m0, s39, 95232
    s_nop 0
    buffer_load_dwordx4 v12, s[16:19], s33 offen nt lds
    s_add_u32 s33, s36, 917504
    s_add_u32 m0, s39, 66560
    s_nop 0
    buffer_load_dwordx4 v12, s[12:15], s33 offen nt lds
    s_add_u32 s33, s56, 917504
    s_add_u32 m0, s39, 99328
    s_nop 0
    buffer_load_dwordx4 v12, s[16:19], s33 offen nt lds
    s_add_u32 s33, s36, 1146880
    s_add_u32 m0, s39, 70656
    s_nop 0
    buffer_load_dwordx4 v12, s[12:15], s33 offen nt lds
    s_add_u32 s33, s56, 1146880
    s_add_u32 m0, s39, 103424
    s_nop 0
    buffer_load_dwordx4 v12, s[16:19], s33 offen nt lds
    s_waitcnt vmcnt(4)
    s_add_u32 s33, s36, 1376256
    s_add_u32 m0, s39, 74752
    s_nop 0
    buffer_load_dwordx4 v12, s[12:15], s33 offen nt lds
    s_waitcnt vmcnt(4)
    s_add_u32 s33, s56, 1376256
    s_add_u32 m0, s39, 107520
    s_nop 0
    buffer_load_dwordx4 v12, s[16:19], s33 offen nt lds
    s_waitcnt vmcnt(4)
    s_add_u32 s33, s36, 1605632
    s_add_u32 m0, s39, 78848
    s_nop 0
    buffer_load_dwordx4 v12, s[12:15], s33 offen nt lds
    s_waitcnt vmcnt(4)
    s_add_u32 s33, s56, 1605632
    s_add_u32 m0, s39, 111616
    s_nop 0
    buffer_load_dwordx4 v12, s[16:19], s33 offen nt lds
    s_waitcnt vmcnt(4)
    s_waitcnt vmcnt(0)
    s_mov_b64 exec, 1
    ds_add_u32 v164, v165 offset:100
    s_mov_b64 exec, -1
m_h6:
    ds_read_b32 v9, v164 offset:84
    s_waitcnt lgkmcnt(0)
    v_cmp_gt_u32 vcc, 12, v9
    s_add_u32 s58, s58, 1
    s_cmp_gt_u32 s58, 2097152
    s_cbranch_scc1 m_h6_x
    s_cbranch_vccz m_h6_x
    s_sleep 1
    s_branch m_h6
m_h6_x:
    s_add_u32 s33, s37, 98304
    s_add_u32 m0, s39, 140288
    s_nop 0
    buffer_load_dwordx4 v13, s[20:23], s33 offen nt lds
    s_add_u32 s33, s37, 114688
    s_add_u32 m0, s39, 144384
    s_nop 0
    buffer_load_dwordx4 v14, s[20:23], s33 offen nt lds
    s_waitcnt vmcnt(0)
k3_fin:
m_end:
    s_endpgm
.section .rodata,"a"
.p2align 6
.amdhsa_kernel sequential_preLN__spectral_gfnet__moe_arch_mod__prompt_kernel
  .amdhsa_next_free_vgpr 168
  .amdhsa_next_free_sgpr 102
  .amdhsa_accum_offset 168
  .amdhsa_group_segment_fixed_size 0
  .amdhsa_kernarg_size 88
  .amdhsa_user_sgpr_count 2
  .amdhsa_user_sgpr_kernarg_segment_ptr 1
  .amdhsa_system_sgpr_workgroup_id_x 1
  .amdhsa_float_denorm_mode_32 3
.end_amdhsa_kernel
.section .rodata,"a"
.p2align 8
.type tab1,@object
tab1:
.long 0x3c003c00,0x3c003c00,0x3c003c00,0x3c003c00,0x39a83c00,0xb9a80000,0xb9a8bc00,0x39a80000
.long 0x3c00,0xbc00,0x3c00,0xbc00,0xb9a83c00,0x39a80000,0x39a8bc00,0xb9a80000
.long 0xbc003c00,0xbc003c00,0xbc003c00,0xbc003c00,0xb9a83c00,0x39a80000,0x39a8bc00,0xb9a80000
.long 0x3c00,0xbc00,0x3c00,0xbc00,0x39a83c00,0xb9a80000,0xb9a8bc00,0x39a80000
.long 0x3c003c00,0x3c003c00,0x3c003c00,0x3c003c00,0x39a83c00,0xb9a80000,0xb9a8bc00,0x39a80000
.long 0x3c00,0xbc00,0x3c00,0xbc00,0xb9a83c00,0x39a80000,0x39a8bc00,0xb9a80000
.long 0xbc003c00,0xbc003c00,0xbc003c00,0xbc003c00,0xb9a83c00,0x39a80000,0x39a8bc00,0xb9a80000
.long 0x3c00,0xbc00,0x3c00,0xbc00,0x39a83c00,0xb9a80000,0xb9a8bc00,0x39a80000
.long 0x3c003c00,0x3c003c00,0x3c003c00,0x3c003c00,0x38723bd9,0xbaa7b23e,0xb872bbd9,0x3aa7323e
.long 0xb61f3b64,0x361fbb64,0xb61f3b64,0x361fbb64,0xbbd93aa7,0x323e3872,0x3bd9baa7,0xb23eb872
.long 0xb9a839a8,0xb9a839a8,0xb9a839a8,0xb9a839a8,0x323e3872,0x3bd9baa7,0xb23eb872,0xbbd93aa7
.long 0x3b64361f,0xbb64b61f,0x3b64361f,0xbb64b61f,0x3aa7323e,0x38723bd9,0xbaa7b23e,0xb872bbd9
.long 0x0,0x0,0x0,0x0,0xbaa7b23e,0xb872bbd9,0x3aa7323e,0x38723bd9
.long 0xbb64b61f,0x3b64361f,0xbb64b61f,0x3b64361f,0xb23eb872,0xbbd93aa7,0x323e3872,0x3bd9baa7
.long 0x39a8b9a8,0x39a8b9a8,0x39a8b9a8,0x39a8b9a8,0x3bd9baa7,0xb23eb872,0xbbd93aa7,0x323e3872
.long 0x361fbb64,0xb61f3b64,0x361fbb64,0xb61f3b64,0xb872bbd9,0x3aa7323e,0x38723bd9,0xbaa7b23e
.long 0x3c003c00,0x3c003c00,0x3c003c00,0x3c003c00,0x361f3b64,0xbb64b61f,0xb61fbb64,0x3b64361f
.long 0xb9a839a8,0x39a8b9a8,0xb9a839a8,0x39a8b9a8,0xbb64361f,0xb61f3b64,0x3b64b61f,0x361fbb64
.long 0x0,0x0,0x0,0x0,0x3b64b61f,0x361fbb64,0xbb64361f,0xb61f3b64
.long 0x39a8b9a8,0xb9a839a8,0x39a8b9a8,0xb9a839a8,0xb61fbb64,0x3b64361f,0x361f3b64,0xbb64b61f
.long 0xbc00bc00,0xbc00bc00,0xbc00bc00,0xbc00bc00,0xb61fbb64,0x3b64361f,0x361f3b64,0xbb64b61f
.long 0x39a8b9a8,0xb9a839a8,0x39a8b9a8,0xb9a839a8,0x3b64b61f,0x361fbb64,0xbb64361f,0xb61f3b64
.long 0x0,0x0,0x0,0x0,0xbb64361f,0xb61f3b64,0x3b64b61f,0x361fbb64
.long 0xb9a839a8,0x39a8b9a8,0xb9a839a8,0x39a8b9a8,0x361f3b64,0xbb64b61f,0xb61fbb64,0x3b64361f
.long 0x3c003c00,0x3c003c00,0x3c003c00,0x3c003c00,0x323e3aa7,0xbbd9b872,0xb23ebaa7,0x3bd93872
.long 0xbb64361f,0x3b64b61f,0xbb64361f,0x3b64b61f,0xb872b23e,0xbaa73bd9,0x3872323e,0x3aa7bbd9
.long 0x39a8b9a8,0x39a8b9a8,0x39a8b9a8,0x39a8b9a8,0x3aa7bbd9,0xb872b23e,0xbaa73bd9,0x3872323e
.long 0xb61fbb64,0x361f3b64,0xb61fbb64,0x361f3b64,0xbbd9b872,0xb23ebaa7,0x3bd93872,0x323e3aa7
.long 0x0,0x0,0x0,0x0,0x3bd93872,0x323e3aa7,0xbbd9b872,0xb23ebaa7
.long 0x361f3b64,0xb61fbb64,0x361f3b64,0xb61fbb64,0xbaa73bd9,0x3872323e,0x3aa7bbd9,0xb872b23e
.long 0xb9a839a8,0xb9a839a8,0xb9a839a8,0xb9a839a8,0x3872323e,0x3aa7bbd9,0xb872b23e,0xbaa73bd9
.long 0x3b64b61f,0xbb64361f,0x3b64b61f,0xbb64361f,0xb23ebaa7,0x3bd93872,0x323e3aa7,0xbbd9b872
.long 0x80008000,0x80008000,0x80008000,0x80008000,0xb9a88000,0xb9a8bc00,0x39a88000,0x39a83c00
.long 0xbc008000,0x3c008000,0xbc008000,0x3c008000,0xb9a88000,0xb9a83c00,0x39a88000,0x39a8bc00
.long 0x80008000,0x80008000,0x80008000,0x80008000,0x39a88000,0x39a8bc00,0xb9a88000,0xb9a83c00
.long 0x3c008000,0xbc008000,0x3c008000,0xbc008000,0x39a88000,0x39a83c00,0xb9a88000,0xb9a8bc00
.long 0x80008000,0x80008000,0x80008000,0x80008000,0xb9a88000,0xb9a8bc00,0x39a88000,0x39a83c00
.long 0xbc008000,0x3c008000,0xbc008000,0x3c008000,0xb9a88000,0xb9a83c00,0x39a88000,0x39a8bc00
.long 0x80008000,0x80008000,0x80008000,0x80008000,0x39a88000,0x39a8bc00,0xb9a88000,0xb9a83c00
.long 0x3c008000,0xbc008000,0x3c008000,0xbc008000,0x39a88000,0x39a83c00,0xb9a88000,0xb9a8bc00
.long 0x80008000,0x80008000,0x80008000,0x80008000,0xbaa7b23e,0xb872bbd9,0x3aa7323e,0x38723bd9
.long 0xbb64b61f,0x3b64361f,0xbb64b61f,0x3b64361f,0xb23eb872,0xbbd93aa7,0x323e3872,0x3bd9baa7
.long 0x39a8b9a8,0x39a8b9a8,0x39a8b9a8,0x39a8b9a8,0x3bd9baa7,0xb23eb872,0xbbd93aa7,0x323e3872
.long 0x361fbb64,0xb61f3b64,0x361fbb64,0xb61f3b64,0xb872bbd9,0x3aa7323e,0x38723bd9,0xbaa7b23e
.long 0xbc00bc00,0xbc00bc00,0xbc00bc00,0xbc00bc00,0xb872bbd9,0x3aa7323e,0x38723bd9,0xbaa7b23e
.long 0x361fbb64,0xb61f3b64,0x361fbb64,0xb61f3b64,0x3bd9baa7,0xb23eb872,0xbbd93aa7,0x323e3872
.long 0x39a8b9a8,0x39a8b9a8,0x39a8b9a8,0x39a8b9a8,0xb23eb872,0xbbd93aa7,0x323e3872,0x3bd9baa7
.long 0xbb64b61f,0x3b64361f,0xbb64b61f,0x3b64361f,0xbaa7b23e,0xb872bbd9,0x3aa7323e,0x38723bd9
.long 0x80008000,0x80008000,0x80008000,0x80008000,0xbb64b61f,0xb61fbb64,0x3b64361f,0x361f3b64
.long 0xb9a8b9a8,0x39a839a8,0xb9a8b9a8,0x39a839a8,0x361fbb64,0xbb64361f,0xb61f3b64,0x3b64b61f
.long 0x3c00bc00,0x3c00bc00,0x3c00bc00,0x3c00bc00,0x361fbb64,0xbb64361f,0xb61f3b64,0x3b64b61f
.long 0xb9a8b9a8,0x39a839a8,0xb9a8b9a8,0x39a839a8,0xbb64b61f,0xb61fbb64,0x3b64361f,0x361f3b64
.long 0x80008000,0x80008000,0x80008000,0x80008000,0x3b64361f,0x361f3b64,0xbb64b61f,0xb61fbb64
.long 0x39a839a8,0xb9a8b9a8,0x39a839a8,0xb9a8b9a8,0xb61f3b64,0x3b64b61f,0x361fbb64,0xbb64361f
.long 0xbc003c00,0xbc003c00,0xbc003c00,0xbc003c00,0xb61f3b64,0x3b64b61f,0x361fbb64,0xbb64361f
.long 0x39a839a8,0xb9a8b9a8,0x39a839a8,0xb9a8b9a8,0x3b64361f,0x361f3b64,0xbb64b61f,0xb61fbb64
.long 0x80008000,0x80008000,0x80008000,0x80008000,0xbbd9b872,0xb23ebaa7,0x3bd93872,0x323e3aa7
.long 0xb61fbb64,0x361f3b64,0xb61fbb64,0x361f3b64,0x3aa7bbd9,0xb872b23e,0xbaa73bd9,0x3872323e
.long 0x39a8b9a8,0x39a8b9a8,0x39a8b9a8,0x39a8b9a8,0xb872b23e,0xbaa73bd9,0x3872323e,0x3aa7bbd9
.long 0xbb64361f,0x3b64b61f,0xbb64361f,0x3b64b61f,0x323e3aa7,0xbbd9b872,0xb23ebaa7,0x3bd93872
.long 0x3c003c00,0x3c003c00,0x3c003c00,0x3c003c00,0x323e3aa7,0xbbd9b872,0xb23ebaa7,0x3bd93872
.long 0xbb64361f,0x3b64b61f,0xbb64361f,0x3b64b61f,0xb872b23e,0xbaa73bd9,0x3872323e,0x3aa7bbd9
.long 0x39a8b9a8,0x39a8b9a8,0x39a8b9a8,0x39a8b9a8,0x3aa7bbd9,0xb872b23e,0xbaa73bd9,0x3872323e
.long 0xb61fbb64,0x361f3b64,0xb61fbb64,0x361f3b64,0xbbd9b872,0xb23ebaa7,0x3bd93872,0x323e3aa7
.long 0x3c003c00,0x3c003c00,0x3c003c00,0x3c003c00,0x39a83c00,0xb9a80000,0xb9a8bc00,0x39a80000
.long 0x3c00,0xbc00,0x3c00,0xbc00,0xb9a83c00,0x39a80000,0x39a8bc00,0xb9a80000
.long 0xbc003c00,0xbc003c00,0xbc003c00,0xbc003c00,0xb9a83c00,0x39a80000,0x39a8bc00,0xb9a80000
.long 0x3c00,0xbc00,0x3c00,0xbc00,0x39a83c00,0xb9a80000,0xb9a8bc00,0x39a80000
.long 0x3c003c00,0x3c003c00,0x3c003c00,0x3c003c00,0x39a83c00,0xb9a80000,0xb9a8bc00,0x39a80000
.long 0x3c00,0xbc00,0x3c00,0xbc00,0xb9a83c00,0x39a80000,0x39a8bc00,0xb9a80000
.long 0xbc003c00,0xbc003c00,0xbc003c00,0xbc003c00,0xb9a83c00,0x39a80000,0x39a8bc00,0xb9a80000
.long 0x3c00,0xbc00,0x3c00,0xbc00,0x39a83c00,0xb9a80000,0xb9a8bc00,0x39a80000
.long 0xbc00bc00,0xbc00bc00,0xbc00bc00,0xbc00bc00,0xb872bbd9,0x3aa7323e,0x38723bd9,0xbaa7b23e
.long 0x361fbb64,0xb61f3b64,0x361fbb64,0xb61f3b64,0x3bd9baa7,0xb23eb872,0xbbd93aa7,0x323e3872
.long 0x39a8b9a8,0x39a8b9a8,0x39a8b9a8,0x39a8b9a8,0xb23eb872,0xbbd93aa7,0x323e3872,0x3bd9baa7
.long 0xbb64b61f,0x3b64361f,0xbb64b61f,0x3b64361f,0xbaa7b23e,0xb872bbd9,0x3aa7323e,0x38723bd9
.long 0x0,0x0,0x0,0x0,0x3aa7323e,0x38723bd9,0xbaa7b23e,0xb872bbd9
.long 0x3b64361f,0xbb64b61f,0x3b64361f,0xbb64b61f,0x323e3872,0x3bd9baa7,0xb23eb872,0xbbd93aa7
.long 0xb9a839a8,0xb9a839a8,0xb9a839a8,0xb9a839a8,0xbbd93aa7,0x323e3872,0x3bd9baa7,0xb23eb872
.long 0xb61f3b64,0x361fbb64,0xb61f3b64,0x361fbb64,0x38723bd9,0xbaa7b23e,0xb872bbd9,0x3aa7323e
.long 0x3c003c00,0x3c003c00,0x3c003c00,0x3c003c00,0x361f3b64,0xbb64b61f,0xb61fbb64,0x3b64361f
.long 0xb9a839a8,0x39a8b9a8,0xb9a839a8,0x39a8b9a8,0xbb64361f,0xb61f3b64,0x3b64b61f,0x361fbb64
.long 0x0,0x0,0x0,0x0,0x3b64b61f,0x361fbb64,0xbb64361f,0xb61f3b64
.long 0x39a8b9a8,0xb9a839a8,0x39a8b9a8,0xb9a839a8,0xb61fbb64,0x3b64361f,0x361f3b64,0xbb64b61f
.long 0xbc00bc00,0xbc00bc00,0xbc00bc00,0xbc00bc00,0xb61fbb64,0x3b64361f,0x361f3b64,0xbb64b61f
.long 0x39a8b9a8,0xb9a839a8,0x39a8b9a8,0xb9a839a8,0x3b64b61f,0x361fbb64,0xbb64361f,0xb61f3b64
.long 0x0,0x0,0x0,0x0,0xbb64361f,0xb61f3b64,0x3b64b61f,0x361fbb64
.long 0xb9a839a8,0x39a8b9a8,0xb9a839a8,0x39a8b9a8,0x361f3b64,0xbb64b61f,0xb61fbb64,0x3b64361f
.long 0xbc00bc00,0xbc00bc00,0xbc00bc00,0xbc00bc00,0xb23ebaa7,0x3bd93872,0x323e3aa7,0xbbd9b872
.long 0x3b64b61f,0xbb64361f,0x3b64b61f,0xbb64361f,0x3872323e,0x3aa7bbd9,0xb872b23e,0xbaa73bd9
.long 0xb9a839a8,0xb9a839a8,0xb9a839a8,0xb9a839a8,0xbaa73bd9,0x3872323e,0x3aa7bbd9,0xb872b23e
.long 0x361f3b64,0xb61fbb64,0x361f3b64,0xb61fbb64,0x3bd93872,0x323e3aa7,0xbbd9b872,0xb23ebaa7
.long 0x0,0x0,0x0,0x0,0xbbd9b872,0xb23ebaa7,0x3bd93872,0x323e3aa7
.long 0xb61fbb64,0x361f3b64,0xb61fbb64,0x361f3b64,0x3aa7bbd9,0xb872b23e,0xbaa73bd9,0x3872323e
.long 0x39a8b9a8,0x39a8b9a8,0x39a8b9a8,0x39a8b9a8,0xb872b23e,0xbaa73bd9,0x3872323e,0x3aa7bbd9
.long 0xbb64361f,0x3b64b61f,0xbb64361f,0x3b64b61f,0x323e3aa7,0xbbd9b872,0xb23ebaa7,0x3bd93872
.long 0x80008000,0x80008000,0x80008000,0x80008000,0xb9a88000,0xb9a8bc00,0x39a88000,0x39a83c00
.long 0xbc008000,0x3c008000,0xbc008000,0x3c008000,0xb9a88000,0xb9a83c00,0x39a88000,0x39a8bc00
.long 0x80008000,0x80008000,0x80008000,0x80008000,0x39a88000,0x39a8bc00,0xb9a88000,0xb9a83c00
.long 0x3c008000,0xbc008000,0x3c008000,0xbc008000,0x39a88000,0x39a83c00,0xb9a88000,0xb9a8bc00
.long 0x80008000,0x80008000,0x80008000,0x80008000,0xb9a88000,0xb9a8bc00,0x39a88000,0x39a83c00
.long 0xbc008000,0x3c008000,0xbc008000,0x3c008000,0xb9a88000,0xb9a83c00,0x39a88000,0x39a8bc00
.long 0x80008000,0x80008000,0x80008000,0x80008000,0x39a88000,0x39a8bc00,0xb9a88000,0xb9a83c00
.long 0x3c008000,0xbc008000,0x3c008000,0xbc008000,0x39a88000,0x39a83c00,0xb9a88000,0xb9a8bc00
.long 0x80008000,0x80008000,0x80008000,0x80008000,0x3aa7323e,0x38723bd9,0xbaa7b23e,0xb872bbd9
.long 0x3b64361f,0xbb64b61f,0x3b64361f,0xbb64b61f,0x323e3872,0x3bd9baa7,0xb23eb872,0xbbd93aa7
.long 0xb9a839a8,0xb9a839a8,0xb9a839a8,0xb9a839a8,0xbbd93aa7,0x323e3872,0x3bd9baa7,0xb23eb872
.long 0xb61f3b64,0x361fbb64,0xb61f3b64,0x361fbb64,0x38723bd9,0xbaa7b23e,0xb872bbd9,0x3aa7323e
.long 0x3c003c00,0x3c003c00,0x3c003c00,0x3c003c00,0x38723bd9,0xbaa7b23e,0xb872bbd9,0x3aa7323e
.long 0xb61f3b64,0x361fbb64,0xb61f3b64,0x361fbb64,0xbbd93aa7,0x323e3872,0x3bd9baa7,0xb23eb872
.long 0xb9a839a8,0xb9a839a8,0xb9a839a8,0xb9a839a8,0x323e3872,0x3bd9baa7,0xb23eb872,0xbbd93aa7
.long 0x3b64361f,0xbb64b61f,0x3b64361f,0xbb64b61f,0x3aa7323e,0x38723bd9,0xbaa7b23e,0xb872bbd9
.long 0x80008000,0x80008000,0x80008000,0x80008000,0xbb64b61f,0xb61fbb64,0x3b64361f,0x361f3b64
.long 0xb9a8b9a8,0x39a839a8,0xb9a8b9a8,0x39a839a8,0x361fbb64,0xbb64361f,0xb61f3b64,0x3b64b61f
.long 0x3c00bc00,0x3c00bc00,0x3c00bc00,0x3c00bc00,0x361fbb64,0xbb64361f,0xb61f3b64,0x3b64b61f
.long 0xb9a8b9a8,0x39a839a8,0xb9a8b9a8,0x39a839a8,0xbb64b61f,0xb61fbb64,0x3b64361f,0x361f3b64
.long 0x80008000,0x80008000,0x80008000,0x80008000,0x3b64361f,0x361f3b64,0xbb64b61f,0xb61fbb64
.long 0x39a839a8,0xb9a8b9a8,0x39a839a8,0xb9a8b9a8,0xb61f3b64,0x3b64b61f,0x361fbb64,0xbb64361f
.long 0xbc003c00,0xbc003c00,0xbc003c00,0xbc003c00,0xb61f3b64,0x3b64b61f,0x361fbb64,0xbb64361f
.long 0x39a839a8,0xb9a8b9a8,0x39a839a8,0xb9a8b9a8,0x3b64361f,0x361f3b64,0xbb64b61f,0xb61fbb64
.long 0x80008000,0x80008000,0x80008000,0x80008000,0x3bd93872,0x323e3aa7,0xbbd9b872,0xb23ebaa7
.long 0x361f3b64,0xb61fbb64,0x361f3b64,0xb61fbb64,0xbaa73bd9,0x3872323e,0x3aa7bbd9,0xb872b23e
.long 0xb9a839a8,0xb9a839a8,0xb9a839a8,0xb9a839a8,0x3872323e,0x3aa7bbd9,0xb872b23e,0xbaa73bd9
.long 0x3b64b61f,0xbb64361f,0x3b64b61f,0xbb64361f,0xb23ebaa7,0x3bd93872,0x323e3aa7,0xbbd9b872
.long 0xbc00bc00,0xbc00bc00,0xbc00bc00,0xbc00bc00,0xb23ebaa7,0x3bd93872,0x323e3aa7,0xbbd9b872
.long 0x3b64b61f,0xbb64361f,0x3b64b61f,0xbb64361f,0x3872323e,0x3aa7bbd9,0xb872b23e,0xbaa73bd9
.long 0xb9a839a8,0xb9a839a8,0xb9a839a8,0xb9a839a8,0xbaa73bd9,0x3872323e,0x3aa7bbd9,0xb872b23e
.long 0x361f3b64,0xb61fbb64,0x361f3b64,0xb61fbb64,0x3bd93872,0x323e3aa7,0xbbd9b872,0xb23ebaa7
.long 0x3f800000,0x3f800000,0x3f800000,0x3f800000,0x3f800000,0x3f7ffb11,0x3f7fec43,0x3f7fd397
.long 0x3f800000,0x3f7fec43,0x3f7fb10f,0x3f7f4e6d,0x3f800000,0x3f7fd397,0x3f7f4e6d,0x3f7e70b0
.long 0x3f800000,0x3f7fb10f,0x3f7ec46d,0x3f7d3aac,0x3f800000,0x3f7f84ab,0x3f7e1324,0x3f7baccd
.long 0x3f800000,0x3f7f4e6d,0x3f7d3aac,0x3f79c79d,0x3f800000,0x3f7f0e58,0x3f7c3b28,0x3f778bc5
.long 0x3f800000,0x3f7ec46d,0x3f7b14be,0x3f74fa0b,0x3f800000,0x3f7e70b0,0x3f79c79d,0x3f721352
.long 0x3f800000,0x3f7e1324,0x3f7853f8,0x3f6ed89e,0x3f800000,0x3f7dabcc,0x3f76ba07,0x3f6b4b0c
.long 0x3f800000,0x3f7d3aac,0x3f74fa0b,0x3f676bd8,0x3f800000,0x3f7cbfc9,0x3f731447,0x3f633c5a
.long 0x3f800000,0x3f7c3b28,0x3f710908,0x3f5ebe05,0x3f800000,0x3f7baccd,0x3f6ed89e,0x3f59f26a
.long 0x3f800000,0x3f800000,0x3f800000,0x3f800000,0x3f7fb10f,0x3f7f84ab,0x3f7f4e6d,0x3f7f0e58
.long 0x3f7ec46d,0x3f7e1324,0x3f7d3aac,0x3f7c3b28,0x3f7d3aac,0x3f7baccd,0x3f79c79d,0x3f778bc5
.long 0x3f7b14be,0x3f7853f8,0x3f74fa0b,0x3f710908,0x3f7853f8,0x3f740bdd,0x3f6ed89e,0x3f68bf3c
.long 0x3f74fa0b,0x3f6ed89e,0x3f676bd8,0x3f5ebe05,0x3f710908,0x3f68bf3c,0x3f5ebe05,0x3f531849
.long 0x3f6c835e,0x3f61c598,0x3f54db31,0x3f45e403,0x3f676bd8,0x3f59f26a,0x3f49d112,0x3f373a23
.long 0x3f61c598,0x3f514d3d,0x3f3daef9,0x3f273656,0x3f5b941a,0x3f47de65,0x3f3085bb,0x3f15f6d9
.long 0x3f54db31,0x3f3daef9,0x3f226799,0x3f039c3d,0x3f4d9f02,0x3f32c8c9,0x3f13682a,0x3ee0924f
.long 0x3f45e403,0x3f273656,0x3f039c3d,0x3eb8442a,0x3f3daef9,0x3f1b02c6,0x3ee63375,0x3e8e9a22
.long 0x3f800000,0x3f800000,0x3f800000,0x3f800000,0x3f7ec46d,0x3f7e70b0,0x3f7e1324,0x3f7dabcc
.long 0x3f7b14be,0x3f79c79d,0x3f7853f8,0x3f76ba07,0x3f74fa0b,0x3f721352,0x3f6ed89e,0x3f6b4b0c
.long 0x3f6c835e,0x3f676bd8,0x3f61c598,0x3f5b941a,0x3f61c598,0x3f59f26a,0x3f514d3d,0x3f47de65
.long 0x3f54db31,0x3f49d112,0x3f3daef9,0x3f3085bb,0x3f45e403,0x3f373a23,0x3f273656,0x3f15f6d9
.long 0x3f3504f3,0x3f226799,0x3f0e39da,0x3ef15aea,0x3f226799,0x3f0b9a6b,0x3ee63375,0x3eb263ef
.long 0x3f0e39da,0x3ee63375,0x3eac7cd4,0x3e605c13,0x3ef15aea,0x3eb263ef,0x3e605c13,0x3dafb680
.long 0x3ec3ef15,0x3e78cfcc,0x3dc8bd36,0xbd48fb30,0x3e94a031,0x3e09cf86,0xbcc90ab0,0xbe3b6ecf
.long 0x3e47c5c2,0x3cc90ab0,0xbe164083,0xbea09ae5,0x3dc8bd36,0xbdafb680,0xbe888e93,0xbee0924f
.long 0x3f800000,0x3f800000,0x3f800000,0x3f800000,0x3f7d3aac,0x3f7cbfc9,0x3f7c3b28,0x3f7baccd
.long 0x3f74fa0b,0x3f731447,0x3f710908,0x3f6ed89e,0x3f676bd8,0x3f633c5a,0x3f5ebe05,0x3f59f26a
.long 0x3f54db31,0x3f4d9f02,0x3f45e403,0x3f3daef9,0x3f3daef9,0x3f32c8c9,0x3f273656,0x3f1b02c6
.long 0x3f226799,0x3f13682a,0x3f039c3d,0x3ee63375,0x3f039c3d,0x3ee0924f,0x3eb8442a,0x3e8e9a22
.long 0x3ec3ef15,0x3e94a031,0x3e47c5c2,0x3dc8bd36,0x3e78cfcc,0x3e09cf86,0x3cc90ab0,0xbdafb680
.long 0x3dc8bd36,0xbcc90ab0,0xbe164083,0xbe888e93,0xbd48fb30,0xbe3b6ecf,0xbea09ae5,0xbee0924f
.long 0xbe47c5c2,0xbeac7cd4,0xbef15aea,0xbf187fc0,0xbeac7cd4,0xbef6e0cb,0xbf1d7fd1,0xbf3b8f3b
.long 0xbef15aea,0xbf1d7fd1,0xbf3daef9,0xbf584853,0xbf187fc0,0xbf3b8f3b,0xbf584853,0xbf6db293
.long 0x80000000,0x80000000,0x80000000,0x80000000,0x80000000,0xbc490e90,0xbcc90ab0,0xbd16c32c
.long 0x80000000,0xbcc90ab0,0xbd48fb30,0xbd96a905,0x80000000,0xbd16c32c,0xbd96a905,0xbde1bc2e
.long 0x80000000,0xbd48fb30,0xbdc8bd36,0xbe164083,0x80000000,0xbd7b2b74,0xbdfab273,0xbe3b6ecf
.long 0x80000000,0xbd96a905,0xbe164083,0xbe605c13,0x80000000,0xbdafb680,0xbe2f10a2,0xbe827dc0
.long 0x80000000,0xbdc8bd36,0xbe47c5c2,0xbe94a031,0x80000000,0xbde1bc2e,0xbe605c13,0xbea68f12
.long 0x80000000,0xbdfab273,0xbe78cfcc,0xbeb8442a,0x80000000,0xbe09cf86,0xbe888e93,0xbec9b953
.long 0x80000000,0xbe164083,0xbe94a031,0xbedae880,0x80000000,0xbe22abb6,0xbea09ae5,0xbeebcbbb
.long 0x80000000,0xbe2f10a2,0xbeac7cd4,0xbefc5d27,0x80000000,0xbe3b6ecf,0xbeb8442a,0xbf064b82
.long 0x80000000,0x80000000,0x80000000,0x80000000,0xbd48fb30,0xbd7b2b74,0xbd96a905,0xbdafb680
.long 0xbdc8bd36,0xbdfab273,0xbe164083,0xbe2f10a2,0xbe164083,0xbe3b6ecf,0xbe605c13,0xbe827dc0
.long 0xbe47c5c2,0xbe78cfcc,0xbe94a031,0xbeac7cd4,0xbe78cfcc,0xbe9aa086,0xbeb8442a,0xbed53641
.long 0xbe94a031,0xbeb8442a,0xbedae880,0xbefc5d27,0xbeac7cd4,0xbed53641,0xbefc5d27,0xbf10d3cd
.long 0xbec3ef15,0xbef15aea,0xbf0e39da,0xbf226799,0xbedae880,0xbf064b82,0xbf1d7fd1,0xbf32c8c9
.long 0xbef15aea,0xbf13682a,0xbf2beb4a,0xbf41d870,0xbf039c3d,0xbf1ff6cb,0xbf396842,0xbf4f7a1f
.long 0xbf0e39da,0xbf2beb4a,0xbf45e403,0xbf5b941a,0xbf187fc0,0xbf373a23,0xbf514d3d,0xbf660f88
.long 0xbf226799,0xbf41d870,0xbf5b941a,0xbf6ed89e,0xbf2beb4a,0xbf4bbbf8,0xbf64aa59,0xbf75dec6
.long 0x80000000,0x80000000,0x80000000,0x80000000,0xbdc8bd36,0xbde1bc2e,0xbdfab273,0xbe09cf86
.long 0xbe47c5c2,0xbe605c13,0xbe78cfcc,0xbe888e93,0xbe94a031,0xbea68f12,0xbeb8442a,0xbec9b953
.long 0xbec3ef15,0xbedae880,0xbef15aea,0xbf039c3d,0xbef15aea,0xbf064b82,0xbf13682a,0xbf1ff6cb
.long 0xbf0e39da,0xbf1d7fd1,0xbf2beb4a,0xbf396842,0xbf226799,0xbf32c8c9,0xbf41d870,0xbf4f7a1f
.long 0xbf3504f3,0xbf45e403,0xbf54db31,0xbf61c598,0xbf45e403,0xbf5695e5,0xbf64aa59,0xbf6ff573
.long 0xbf54db31,0xbf64aa59,0xbf710908,0xbf79c79d,0xbf61c598,0xbf6ff573,0xbf79c79d,0xbf7f0e58
.long 0xbf6c835e,0xbf7853f8,0xbf7ec46d,0xbf7fb10f,0xbf74fa0b,0xbf7dabcc,0xbf7fec43,0xbf7baccd
.long 0xbf7b14be,0xbf7fec43,0xbf7d3aac,0xbf731447,0xbf7ec46d,0xbf7f0e58,0xbf76ba07,0xbf660f88
.long 0x80000000,0x80000000,0x80000000,0x80000000,0xbe164083,0xbe22abb6,0xbe2f10a2,0xbe3b6ecf
.long 0xbe94a031,0xbea09ae5,0xbeac7cd4,0xbeb8442a,0xbedae880,0xbeebcbbb,0xbefc5d27,0xbf064b82
.long 0xbf0e39da,0xbf187fc0,0xbf226799,0xbf2beb4a,0xbf2beb4a,0xbf373a23,0xbf41d870,0xbf4bbbf8
.long 0xbf45e403,0xbf514d3d,0xbf5b941a,0xbf64aa59,0xbf5b941a,0xbf660f88,0xbf6ed89e,0xbf75dec6
.long 0xbf6c835e,0xbf74fa0b,0xbf7b14be,0xbf7ec46d,0xbf7853f8,0xbf7dabcc,0xbf7fec43,0xbf7f0e58
.long 0xbf7ec46d,0xbf7fec43,0xbf7d3aac,0xbf76ba07,0xbf7fb10f,0xbf7baccd,0xbf731447,0xbf660f88
.long 0xbf7b14be,0xbf710908,0xbf61c598,0xbf4d9f02,0xbf710908,0xbf604621,0xbf49d112,0xbf2e3bde
.long 0xbf61c598,0xbf49d112,0xbf2beb4a,0xbf08f59b,0xbf4d9f02,0xbf2e3bde,0xbf08f59b,0xbebe1d4a
.long 0x3f800000,0x3f7b14be,0x3f6c835e,0x3f54db31,0x3f800000,0x3f7a7302,0x3f6a09a7,0x3f4f7a1f
.long 0x3f800000,0x3f79c79d,0x3f676bd8,0x3f49d112,0x3f800000,0x3f791298,0x3f64aa59,0x3f43e200
.long 0x3f800000,0x3f7853f8,0x3f61c598,0x3f3daef9,0x3f800000,0x3f778bc5,0x3f5ebe05,0x3f373a23
.long 0x3f800000,0x3f76ba07,0x3f5b941a,0x3f3085bb,0x3f800000,0x3f75dec6,0x3f584853,0x3f299415
.long 0x3f800000,0x3f74fa0b,0x3f54db31,0x3f226799,0x3f800000,0x3f740bdd,0x3f514d3d,0x3f1b02c6
.long 0x3f800000,0x3f731447,0x3f4d9f02,0x3f13682a,0x3f800000,0x3f721352,0x3f49d112,0x3f0b9a6b
.long 0x3f800000,0x3f710908,0x3f45e403,0x3f039c3d,0x3f800000,0x3f6ff573,0x3f41d870,0x3ef6e0cb
.long 0x3f800000,0x3f6ed89e,0x3f3daef9,0x3ee63375,0x3f800000,0x3f6db293,0x3f396842,0x3ed53641
.long 0x3f3504f3,0x3f0e39da,0x3ec3ef15,0x3e47c5c2,0x3f2beb4a,0x3f00e7e4,0x3ea09ae5,0x3de1bc2e
.long 0x3f226799,0x3ee63375,0x3e78cfcc,0x3cc90ab0,0x3f187fc0,0x3ec9b953,0x3e2f10a2,0xbd7b2b74
.long 0x3f0e39da,0x3eac7cd4,0x3dc8bd36,0xbe164083,0x3f039c3d,0x3e8e9a22,0x3cc90ab0,0xbe6c9a7f
.long 0x3ef15aea,0x3e605c13,0xbd48fb30,0xbea09ae5,0x3edae880,0x3e22abb6,0xbdfab273,0xbec9b953
.long 0x3ec3ef15,0x3dc8bd36,0xbe47c5c2,0xbef15aea,0x3eac7cd4,0x3d16c32c,0xbe888e93,0xbf0b9a6b
.long 0x3e94a031,0xbcc90ab0,0xbeac7cd4,0xbf1d7fd1,0x3e78cfcc,0xbdafb680,0xbecf7bca,0xbf2e3bde
.long 0x3e47c5c2,0xbe164083,0xbef15aea,0xbf3daef9,0x3e164083,0xbe541501,0xbf08f59b,0xbf4bbbf8
.long 0x3dc8bd36,0xbe888e93,0xbf187fc0,0xbf584853,0x3d48fb30,0xbea68f12,0xbf273656,0xbf633c5a
.long 0x0,0xbe47c5c2,0xbec3ef15,0xbf0e39da,0xbdc8bd36,0xbe9aa086,0xbefc5d27,0xbf299415
.long 0xbe47c5c2,0xbecf7bca,0xbf187fc0,0xbf41d870,0xbe94a031,0xbf00e7e4,0xbf3085bb,0xbf5695e5
.long 0xbec3ef15,0xbf187fc0,0xbf45e403,0xbf676bd8,0xbef15aea,0xbf2e3bde,0xbf584853,0xbf740bdd
.long 0xbf0e39da,0xbf41d870,0xbf676bd8,0xbf7c3b28,0xbf226799,0xbf531849,0xbf731447,0xbf7fd397
.long 0xbf3504f3,0xbf61c598,0xbf7b14be,0xbf7ec46d,0xbf45e403,0xbf6db293,0xbf7f4e6d,0xbf791298
.long 0xbf54db31,0xbf76ba07,0xbf7fb10f,0xbf6ed89e,0xbf61c598,0xbf7cbfc9,0xbf7c3b28,0xbf604621
.long 0xbf6c835e,0xbf7fb10f,0xbf74fa0b,0xbf4d9f02,0xbf74fa0b,0xbf7f84ab,0xbf6a09a7,0xbf373a23
.long 0xbf7b14be,0xbf7c3b28,0xbf5b941a,0xbf1d7fd1,0xbf7ec46d,0xbf75dec6,0xbf49d112,0xbf00e7e4
.long 0xbf3504f3,0xbf54db31,0xbf6c835e,0xbf7b14be,0xbf4d9f02,0xbf68bf3c,0xbf79c79d,0xbf7ffb11
.long 0xbf61c598,0xbf76ba07,0xbf7fb10f,0xbf7c3b28,0xbf710908,0xbf7e70b0,0xbf7e1324,0xbf6ff573
.long 0xbf7b14be,0xbf7fb10f,0xbf74fa0b,0xbf5b941a,0xbf7fb10f,0xbf7a7302,0xbf64aa59,0xbf3fc767
.long 0xbf7ec46d,0xbf6ed89e,0xbf4d9f02,0xbf1d7fd1,0xbf7853f8,0xbf5d2d53,0xbf3085bb,0xbeebcbbb
.long 0xbf6c835e,0xbf45e403,0xbf0e39da,0xbe94a031,0xbf5b941a,0xbf299415,0xbecf7bca,0xbde1bc2e
.long 0xbf45e403,0xbf08f59b,0xbe78cfcc,0x3d96a905,0xbf2beb4a,0xbec9b953,0xbd96a905,0x3e827dc0
.long 0xbf0e39da,0xbe78cfcc,0x3dc8bd36,0x3edae880,0xbedae880,0xbdafb680,0x3e888e93,0x3f15f6d9
.long 0xbe94a031,0x3d96a905,0x3edae880,0x3f396842,0xbe164083,0x3e6c9a7f,0x3f13682a,0x3f5695e5
.long 0x80000000,0xbe47c5c2,0xbec3ef15,0xbf0e39da,0x80000000,0xbe541501,0xbecf7bca,0xbf15f6d9
.long 0x80000000,0xbe605c13,0xbedae880,0xbf1d7fd1,0x80000000,0xbe6c9a7f,0xbee63375,0xbf24d225
.long 0x80000000,0xbe78cfcc,0xbef15aea,0xbf2beb4a,0x80000000,0xbe827dc0,0xbefc5d27,0xbf32c8c9
.long 0x80000000,0xbe888e93,0xbf039c3d,0xbf396842,0x80000000,0xbe8e9a22,0xbf08f59b,0xbf3fc767
.long 0x80000000,0xbe94a031,0xbf0e39da,0xbf45e403,0x80000000,0xbe9aa086,0xbf13682a,0xbf4bbbf8
.long 0x80000000,0xbea09ae5,0xbf187fc0,0xbf514d3d,0x80000000,0xbea68f12,0xbf1d7fd1,0xbf5695e5
.long 0x80000000,0xbeac7cd4,0xbf226799,0xbf5b941a,0x80000000,0xbeb263ef,0xbf273656,0xbf604621
.long 0x80000000,0xbeb8442a,0xbf2beb4a,0xbf64aa59,0x80000000,0xbebe1d4a,0xbf3085bb,0xbf68bf3c
.long 0xbf3504f3,0xbf54db31,0xbf6c835e,0xbf7b14be,0xbf3daef9,0xbf5d2d53,0xbf731447,0xbf7e70b0
.long 0xbf45e403,0xbf64aa59,0xbf7853f8,0xbf7fec43,0xbf4d9f02,0xbf6b4b0c,0xbf7c3b28,0xbf7f84ab
.long 0xbf54db31,0xbf710908,0xbf7ec46d,0xbf7d3aac,0xbf5b941a,0xbf75dec6,0xbf7fec43,0xbf791298
.long 0xbf61c598,0xbf79c79d,0xbf7fb10f,0xbf731447,0xbf676bd8,0xbf7cbfc9,0xbf7e1324,0xbf6b4b0c
.long 0xbf6c835e,0xbf7ec46d,0xbf7b14be,0xbf61c598,0xbf710908,0xbf7fd397,0xbf76ba07,0xbf5695e5
.long 0xbf74fa0b,0xbf7fec43,0xbf710908,0xbf49d112,0xbf7853f8,0xbf7f0e58,0xbf6a09a7,0xbf3b8f3b
.long 0xbf7b14be,0xbf7d3aac,0xbf61c598,0xbf2beb4a,0xbf7d3aac,0xbf7a7302,0xbf584853,0xbf1b02c6
.long 0xbf7ec46d,0xbf76ba07,0xbf4d9f02,0xbf08f59b,0xbf7fb10f,0xbf721352,0xbf41d870,0xbeebcbbb
.long 0xbf800000,0xbf7b14be,0xbf6c835e,0xbf54db31,0xbf7ec46d,0xbf740bdd,0xbf5ebe05,0xbf3fc767
.long 0xbf7b14be,0xbf6a09a7,0xbf4d9f02,0xbf273656,0xbf74fa0b,0xbf5d2d53,0xbf396842,0xbf0b9a6b
.long 0xbf6c835e,0xbf4d9f02,0xbf226799,0xbedae880,0xbf61c598,0xbf3b8f3b,0xbf08f59b,0xbe9aa086
.long 0xbf54db31,0xbf273656,0xbedae880,0xbe2f10a2,0xbf45e403,0xbf10d3cd,0xbea09ae5,0xbd16c32c
.long 0xbf3504f3,0xbef15aea,0xbe47c5c2,0x3dc8bd36,0xbf226799,0xbebe1d4a,0xbd96a905,0x3e6c9a7f
.long 0xbf0e39da,0xbe888e93,0x3d48fb30,0x3eb8442a,0xbef15aea,0xbe22abb6,0x3e2f10a2,0x3ef6e0cb
.long 0xbec3ef15,0xbd48fb30,0x3e94a031,0x3f187fc0,0xbe94a031,0x3d7b2b74,0x3ecf7bca,0x3f32c8c9
.long 0xbe47c5c2,0x3e2f10a2,0x3f039c3d,0x3f49d112,0xbdc8bd36,0x3e8e9a22,0x3f1d7fd1,0x3f5d2d53
.long 0xbf3504f3,0xbf0e39da,0xbec3ef15,0xbe47c5c2,0xbf187fc0,0xbed53641,0xbe605c13,0xbc490e90
.long 0xbef15aea,0xbe888e93,0xbd48fb30,0x3e2f10a2,0xbeac7cd4,0xbde1bc2e,0x3dfab273,0x3eb263ef
.long 0xbe47c5c2,0x3d48fb30,0x3e94a031,0x3f039c3d,0xbd48fb30,0x3e541501,0x3ee63375,0x3f299415
.long 0x3dc8bd36,0x3eb8442a,0x3f187fc0,0x3f49d112,0x3e78cfcc,0x3f00e7e4,0x3f396842,0x3f633c5a
.long 0x3ec3ef15,0x3f226799,0x3f54db31,0x3f74fa0b,0x3f039c3d,0x3f3fc767,0x3f6a09a7,0x3f7e70b0
.long 0x3f226799,0x3f584853,0x3f7853f8,0x3f7f4e6d,0x3f3daef9,0x3f6b4b0c,0x3f7f4e6d,0x3f778bc5
.long 0x3f54db31,0x3f7853f8,0x3f7ec46d,0x3f676bd8,0x3f676bd8,0x3f7f0e58,0x3f76ba07,0x3f4f7a1f
.long 0x3f74fa0b,0x3f7f4e6d,0x3f676bd8,0x3f3085bb,0x3f7d3aac,0x3f791298,0x3f514d3d,0x3f0b9a6b
.long 0x3f800000,0x3f800000,0x3f800000,0x3f800000,0x3f7ffec4,0x3f7ff4e6,0x3f7fe129,0x3f7fc38f
.long 0x3f7ffb11,0x3f7fd397,0x3f7f84ab,0x3f7f0e58,0x3f7ff4e6,0x3f7f9c18,0x3f7eea9d,0x3f7de0b1
.long 0x3f7fec43,0x3f7f4e6d,0x3f7e1324,0x3f7c3b28,0x3f7fe129,0x3f7eea9d,0x3f7cfe73,0x3f7a1e84
.long 0x3f7fd397,0x3f7e70b0,0x3f7baccd,0x3f778bc5,0x3f7fc38f,0x3f7de0b1,0x3f7a1e84,0x3f748422
.long 0x3f7fb10f,0x3f7d3aac,0x3f7853f8,0x3f710908,0x3f7f9c18,0x3f7c7eb0,0x3f764d97,0x3f6d1c1d
.long 0x3f7f84ab,0x3f7baccd,0x3f740bdd,0x3f68bf3c,0x3f7f6ac7,0x3f7ac516,0x3f718f57,0x3f63f473
.long 0x3f7f4e6d,0x3f79c79d,0x3f6ed89e,0x3f5ebe05,0x3f7f2f9d,0x3f78b47b,0x3f6be858,0x3f591e6a
.long 0x3f7f0e58,0x3f778bc5,0x3f68bf3c,0x3f531849,0x3f7eea9d,0x3f764d97,0x3f655e0b,0x3f4cae79
.long 0x3f800000,0x3f800000,0x3f800000,0x3f800000,0x3f7f9c18,0x3f7f6ac7,0x3f7f2f9d,0x3f7eea9d
.long 0x3f7e70b0,0x3f7dabcc,0x3f7cbfc9,0x3f7baccd,0x3f7c7eb0,0x3f7ac516,0x3f78b47b,0x3f764d97
.long 0x3f79c79d,0x3f76ba07,0x3f731447,0x3f6ed89e,0x3f764d97,0x3f718f57,0x3f6be858,0x3f655e0b
.long 0x3f721352,0x3f6b4b0c,0x3f633c5a,0x3f59f26a,0x3f6d1c1d,0x3f63f473,0x3f591e6a,0x3f4cae79
.long 0x3f676bd8,0x3f5b941a,0x3f4d9f02,0x3f3daef9,0x3f6106f2,0x3f5233c6,0x3f40d0da,0x3f2d1469
.long 0x3f59f26a,0x3f47de65,0x3f32c8c9,0x3f1b02c6,0x3f5233c6,0x3f3ca003,0x3f239da9,0x3f07a136
.long 0x3f49d112,0x3f3085bb,0x3f13682a,0x3ee63375,0x3f40d0da,0x3f239da9,0x3f0242b1,0x3ebb31a0
.long 0x3f373a23,0x3f15f6d9,0x3ee0924f,0x3e8e9a22,0x3f2d1469,0x3f07a136,0x3ebb31a0,0x3e419b37
.long 0x3f800000,0x3f800000,0x3f800000,0x3f800000,0x3f7e9bc9,0x3f7e4323,0x3f7de0b1,0x3f7d7474
.long 0x3f7a7302,0x3f791298,0x3f778bc5,0x3f75dec6,0x3f73913f,0x3f708066,0x3f6d1c1d,0x3f696591
.long 0x3f6a09a7,0x3f64aa59,0x3f5ebe05,0x3f584853,0x3f5df6be,0x3f55b993,0x3f4cae79,0x3f42de29
.long 0x3f4f7a1f,0x3f43e200,0x3f373a23,0x3f299415,0x3f3ebc1b,0x3f2f61a5,0x3f1ebc12,0x3f0cead0
.long 0x3f2beb4a,0x3f187fc0,0x3f039c3d,0x3edae880,0x3f173c07,0x3eff17b2,0x3ecc9b8b,0x3e97a117
.long 0x3f00e7e4,0x3ec9b953,0x3e8e9a22,0x3e22abb6,0x3ed25a09,0x3e919ddd,0x3e1c76de,0x3c96c9b6
.long 0x3ea09ae5,0x3e2f10a2,0x3cc90ab0,0xbdfab273,0x3e5a3997,0x3d621469,0xbdd53db9,0xbe8586ce
.long 0x3de1bc2e,0xbd7b2b74,0xbe6c9a7f,0xbec9b953,0x3bc90f88,0xbe354098,0xbeb554ec,0xbf04f484
.long 0x3f800000,0x3f800000,0x3f800000,0x3f800000,0x3f7cfe73,0x3f7c7eb0,0x3f7bf531,0x3f7b61fc
.long 0x3f740bdd,0x3f721352,0x3f6ff573,0x3f6db293,0x3f655e0b,0x3f6106f2,0x3f5c61c7,0x3f577026
.long 0x3f514d3d,0x3f49d112,0x3f41d870,0x3f396842,0x3f385216,0x3f2d1469,0x3f212ff9,0x3f14b039
.long 0x3f1b02c6,0x3f0b9a6b,0x3ef6e0cb,0x3ed53641,0x3ef41f07,0x3ecc9b8b,0x3ea395c5,0x3e72b651
.long 0x3eac7cd4,0x3e78cfcc,0x3e164083,0x3d48fb30,0x3e419b37,0x3da3308c,0xbcfb49ba,0xbe1008b7
.long 0x3d16c32c,0xbdafb680,0xbe541501,0xbea68f12,0xbdee3876,0xbe7ee6e1,0xbec1071e,0xbeff17b2
.long 0xbe888e93,0xbecf7bca,0xbf08f59b,0xbf273656,0xbed25a09,0xbf0cead0,0xbf2d1469,0xbf48d8b3
.long 0xbf0b9a6b,0xbf2e3bde,0xbf4bbbf8,0xbf633c5a,0xbf2ac082,0xbf4ac77f,0xbf63f473,0xbf756d97
.long 0x80000000,0x80000000,0x80000000,0x80000000,0xbbc90f88,0xbc96c9b6,0xbcfb49ba,0xbd2fe007
.long 0xbc490e90,0xbd16c32c,0xbd7b2b74,0xbdafb680,0xbc96c9b6,0xbd621469,0xbdbc3ac3,0xbe039502
.long 0xbcc90ab0,0xbd96a905,0xbdfab273,0xbe2f10a2,0xbcfb49ba,0xbdbc3ac3,0xbe1c76de,0xbe5a3997
.long 0xbd16c32c,0xbde1bc2e,0xbe3b6ecf,0xbe827dc0,0xbd2fe007,0xbe039502,0xbe5a3997,0xbe97a117
.long 0xbd48fb30,0xbe164083,0xbe78cfcc,0xbeac7cd4,0xbd621469,0xbe28defc,0xbe8b9507,0xbec1071e
.long 0xbd7b2b74,0xbe3b6ecf,0xbe9aa086,0xbed53641,0xbd8a200a,0xbe4dee60,0xbea986c4,0xbee900b7
.long 0xbd96a905,0xbe605c13,0xbeb8442a,0xbefc5d27,0xbda3308c,0xbe72b651,0xbec6d529,0xbf07a136
.long 0xbdafb680,0xbe827dc0,0xbed53641,0xbf10d3cd,0xbdbc3ac3,0xbe8b9507,0xbee363fa,0xbf19c200
.long 0x80000000,0x80000000,0x80000000,0x80000000,0xbd621469,0xbd8a200a,0xbda3308c,0xbdbc3ac3
.long 0xbde1bc2e,0xbe09cf86,0xbe22abb6,0xbe3b6ecf,0xbe28defc,0xbe4dee60,0xbe72b651,0xbe8b9507
.long 0xbe605c13,0xbe888e93,0xbea09ae5,0xbeb8442a,0xbe8b9507,0xbea986c4,0xbec6d529,0xbee363fa
.long 0xbea68f12,0xbec9b953,0xbeebcbbb,0xbf064b82,0xbec1071e,0xbee900b7,0xbf07a136,0xbf19c200
.long 0xbedae880,0xbf039c3d,0xbf187fc0,0xbf2beb4a,0xbef41f07,0xbf121eb0,0xbf286605,0xbf3ca003
.long 0xbf064b82,0xbf1ff6cb,0xbf373a23,0xbf4bbbf8,0xbf121eb0,0xbf2d1469,0xbf44e3f5,0xbf591e6a
.long 0xbf1d7fd1,0xbf396842,0xbf514d3d,0xbf64aa59,0xbf286605,0xbf44e3f5,0xbf5c61c7,0xbf6e46be
.long 0xbf32c8c9,0xbf4f7a1f,0xbf660f88,0xbf75dec6,0xbf3ca003,0xbf591e6a,0xbf6e46be,0xbf7b61fc
.long 0x80000000,0x80000000,0x80000000,0x80000000,0xbdd53db9,0xbdee3876,0xbe039502,0xbe1008b7
.long 0xbe541501,0xbe6c9a7f,0xbe827dc0,0xbe8e9a22,0xbe9d9e78,0xbeaf713a,0xbec1071e,0xbed25a09
.long 0xbecf7bca,0xbee63375,0xbefc5d27,0xbf08f59b,0xbeff17b2,0xbf0cead0,0xbf19c200,0xbf26050a
.long 0xbf15f6d9,0xbf24d225,0xbf32c8c9,0xbf3fc767,0xbf2ac082,0xbf3a7ca4,0xbf48d8b3,0xbf55b993
.long 0xbf3daef9,0xbf4d9f02,0xbf5b941a,0xbf676bd8,0xbf4e8d90,0xbf5df6be,0xbf6aab7b,0xbf748422
.long 0xbf5d2d53,0xbf6b4b0c,0xbf75dec6,0xbf7cbfc9,0xbf696591,0xbf756d97,0xbf7cfe73,0xbf7ff4e6
.long 0xbf731447,0xbf7c3b28,0xbf7fec43,0xbf7e1324,0xbf7a1e84,0xbf7f9c18,0xbf7e9bc9,0xbf772417
.long 0xbf7e70b0,0xbf7f84ab,0xbf791298,0xbf6b4b0c,0xbf7ffec4,0xbf7bf531,0xbf6f6830,0xbf5ac450
.long 0x80000000,0x80000000,0x80000000,0x80000000,0xbe1c76de,0xbe28defc,0xbe354098,0xbe419b37
.long 0xbe9aa086,0xbea68f12,0xbeb263ef,0xbebe1d4a,0xbee363fa,0xbef41f07,0xbf0242b1,0xbf0a48ad
.long 0xbf13682a,0xbf1d7fd1,0xbf273656,0xbf3085bb,0xbf31a81d,0xbf3ca003,0xbf46e22a,0xbf5064af
.long 0xbf4bbbf8,0xbf5695e5,0xbf604621,0xbf68bf3c,0xbf6106f2,0xbf6aab7b,0xbf7294f8,0xbf78b47b
.long 0xbf710908,0xbf7853f8,0xbf7d3aac,0xbf7fb10f,0xbf7b61fc,0xbf7f2f9d,0xbf7fe129,0xbf7d7474
.long 0xbf7fd397,0xbf7f0e58,0xbf7a7302,0xbf721352,0xbf7e4323,0xbf77f110,0xbf6d1c1d,0xbf5df6be
.long 0xbf76ba07,0xbf6a09a7,0xbf584853,0xbf41d870,0xbf696591,0xbf55b993,0xbf3ca003,0xbf1ebc12
.long 0xbf5695e5,0xbf3b8f3b,0xbf1b02c6,0xbeebcbbb,0xbf3ebc1b,0xbf1c420c,0xbee900b7,0xbe919ddd
.long 0x3f7ec46d,0x3f74fa0b,0x3f61c598,0x3f45e403,0x3f7e9bc9,0x3f73913f,0x3f5df6be,0x3f3ebc1b
.long 0x3f7e70b0,0x3f721352,0x3f59f26a,0x3f373a23,0x3f7e4323,0x3f708066,0x3f55b993,0x3f2f61a5
.long 0x3f7e1324,0x3f6ed89e,0x3f514d3d,0x3f273656,0x3f7de0b1,0x3f6d1c1d,0x3f4cae79,0x3f1ebc12
.long 0x3f7dabcc,0x3f6b4b0c,0x3f47de65,0x3f15f6d9,0x3f7d7474,0x3f696591,0x3f42de29,0x3f0cead0
.long 0x3f7d3aac,0x3f676bd8,0x3f3daef9,0x3f039c3d,0x3f7cfe73,0x3f655e0b,0x3f385216,0x3ef41f07
.long 0x3f7cbfc9,0x3f633c5a,0x3f32c8c9,0x3ee0924f,0x3f7c7eb0,0x3f6106f2,0x3f2d1469,0x3ecc9b8b
.long 0x3f7c3b28,0x3f5ebe05,0x3f273656,0x3eb8442a,0x3f7bf531,0x3f5c61c7,0x3f212ff9,0x3ea395c5
.long 0x3f7baccd,0x3f59f26a,0x3f1b02c6,0x3e8e9a22,0x3f7b61fc,0x3f577026,0x3f14b039,0x3e72b651
.long 0x3f226799,0x3ef15aea,0x3e94a031,0x3dc8bd36,0x3f173c07,0x3ed25a09,0x3e5a3997,0x3bc90f88
.long 0x3f0b9a6b,0x3eb263ef,0x3e09cf86,0xbdafb680,0x3eff17b2,0x3e919ddd,0x3d621469,0xbe354098
.long 0x3ee63375,0x3e605c13,0xbcc90ab0,0xbe888e93,0x3ecc9b8b,0x3e1c76de,0xbdd53db9,0xbeb554ec
.long 0x3eb263ef,0x3dafb680,0xbe3b6ecf,0xbee0924f,0x3e97a117,0x3c96c9b6,0xbe8586ce,0xbf04f484
.long 0x3e78cfcc,0xbd48fb30,0xbeac7cd4,0xbf187fc0,0x3e419b37,0xbdee3876,0xbed25a09,0xbf2ac082
.long 0x3e09cf86,0xbe3b6ecf,0xbef6e0cb,0xbf3b8f3b,0x3da3308c,0xbe7ee6e1,0xbf0cead0,0xbf4ac77f
.long 0x3cc90ab0,0xbea09ae5,0xbf1d7fd1,0xbf584853,0xbcfb49ba,0xbec1071e,0xbf2d1469,0xbf63f473
.long 0xbdafb680,0xbee0924f,0xbf3b8f3b,0xbf6db293,0xbe1008b7,0xbeff17b2,0xbf48d8b3,0xbf756d97
.long 0xbdc8bd36,0xbe94a031,0xbef15aea,0xbf226799,0xbe4dee60,0xbecc9b8b,0xbf14b039,0xbf3ca003
.long 0xbe9aa086,0xbf00e7e4,0xbf2e3bde,0xbf531849,0xbecc9b8b,0xbf19c200,0xbf44e3f5,0xbf655e0b
.long 0xbefc5d27,0xbf3085bb,0xbf584853,0xbf731447,0xbf14b039,0xbf44e3f5,0xbf6816a8,0xbf7bf531
.long 0xbf299415,0xbf5695e5,0xbf740bdd,0xbf7fd397,0xbf3ca003,0xbf655e0b,0xbf7bf531,0xbf7e9bc9
.long 0xbf4d9f02,0xbf710908,0xbf7fb10f,0xbf7853f8,0xbf5c61c7,0xbf796e4e,0xbf7f2f9d,0xbf6d1c1d
.long 0xbf68bf3c,0xbf7e70b0,0xbf7a7302,0xbf5d2d53,0xbf7294f8,0xbf7ffec4,0xbf718f57,0xbf48d8b3
.long 0xbf79c79d,0xbf7e1324,0xbf64aa59,0xbf3085bb,0xbf7e4323,0xbf78b47b,0xbf53fac3,0xbf14b039
.long 0xbf7ffb11,0xbf6ff573,0xbf3fc767,0xbeebcbbb,0xbf7eea9d,0xbf63f473,0xbf286605,0xbea986c4
.long 0xbf45e403,0xbf61c598,0xbf74fa0b,0xbf7ec46d,0xbf5c61c7,0xbf7294f8,0xbf7e4323,0xbf7eea9d
.long 0xbf6db293,0xbf7cbfc9,0xbf7f84ab,0xbf75dec6,0xbf796e4e,0xbf7ffec4,0xbf78b47b,0xbf63f473
.long 0xbf7f4e6d,0xbf7c3b28,0xbf6a09a7,0xbf49d112,0xbf7f2f9d,0xbf718f57,0xbf53fac3,0xbf286605
.long 0xbf791298,0xbf604621,0xbf373a23,0xbf00e7e4,0xbf6d1c1d,0xbf48d8b3,0xbf14b039,0xbea986c4
.long 0xbf5b941a,0xbf2beb4a,0xbedae880,0xbe164083,0xbf44e3f5,0xbf0a48ad,0xbe8586ce,0x3d2fe007
.long 0xbf299415,0xbec9b953,0xbdafb680,0x3e6c9a7f,0xbf0a48ad,0xbe72b651,0x3dbc3ac3,0x3ed25a09
.long 0xbecf7bca,0xbd96a905,0x3e888e93,0x3f13682a,0xbe8586ce,0x3dbc3ac3,0x3eddbe79,0x3f385216
.long 0xbde1bc2e,0x3e827dc0,0x3f15f6d9,0x3f5695e5,0x3d2fe007,0x3ed25a09,0x3f385216,0x3f6d1c1d
.long 0xbdc8bd36,0xbe94a031,0xbef15aea,0xbf226799,0xbdd53db9,0xbe9d9e78,0xbeff17b2,0xbf2ac082
.long 0xbde1bc2e,0xbea68f12,0xbf064b82,0xbf32c8c9,0xbdee3876,0xbeaf713a,0xbf0cead0,0xbf3a7ca4
.long 0xbdfab273,0xbeb8442a,0xbf13682a,0xbf41d870,0xbe039502,0xbec1071e,0xbf19c200,0xbf48d8b3
.long 0xbe09cf86,0xbec9b953,0xbf1ff6cb,0xbf4f7a1f,0xbe1008b7,0xbed25a09,0xbf26050a,0xbf55b993
.long 0xbe164083,0xbedae880,0xbf2beb4a,0xbf5b941a,0xbe1c76de,0xbee363fa,0xbf31a81d,0xbf6106f2
.long 0xbe22abb6,0xbeebcbbb,0xbf373a23,0xbf660f88,0xbe28defc,0xbef41f07,0xbf3ca003,0xbf6aab7b
.long 0xbe2f10a2,0xbefc5d27,0xbf41d870,0xbf6ed89e,0xbe354098,0xbf0242b1,0xbf46e22a,0xbf7294f8
.long 0xbe3b6ecf,0xbf064b82,0xbf4bbbf8,0xbf75dec6,0xbe419b37,0xbf0a48ad,0xbf5064af,0xbf78b47b
.long 0xbf45e403,0xbf61c598,0xbf74fa0b,0xbf7ec46d,0xbf4e8d90,0xbf696591,0xbf7a1e84,0xbf7ffec4
.long 0xbf5695e5,0xbf6ff573,0xbf7dabcc,0xbf7f0e58,0xbf5df6be,0xbf756d97,0xbf7f9c18,0xbf7bf531
.long 0xbf64aa59,0xbf79c79d,0xbf7fec43,0xbf76ba07,0xbf6aab7b,0xbf7cfe73,0xbf7e9bc9,0xbf6f6830
.long 0xbf6ff573,0xbf7f0e58,0xbf7baccd,0xbf660f88,0xbf748422,0xbf7ff4e6,0xbf772417,0xbf5ac450
.long 0xbf7853f8,0xbf7fb10f,0xbf710908,0xbf4d9f02,0xbf7b61fc,0xbf7e4323,0xbf696591,0xbf3ebc1b
.long 0xbf7dabcc,0xbf7baccd,0xbf604621,0xbf2e3bde,0xbf7f2f9d,0xbf77f110,0xbf55b993,0xbf1c420c
.long 0xbf7fec43,0xbf731447,0xbf49d112,0xbf08f59b,0xbf7fe129,0xbf6d1c1d,0xbf3ca003,0xbee900b7
.long 0xbf7f0e58,0xbf660f88,0xbf2e3bde,0xbebe1d4a,0xbf7d7474,0xbf5df6be,0xbf1ebc12,0xbe919ddd
.long 0xbf7ec46d,0xbf74fa0b,0xbf61c598,0xbf45e403,0xbf7ac516,0xbf6aab7b,0xbf5064af,0xbf2d1469
.long 0xbf740bdd,0xbf5d2d53,0xbf3b8f3b,0xbf10d3cd,0xbf6aab7b,0xbf4cae79,0xbf239da9,0xbee363fa
.long 0xbf5ebe05,0xbf396842,0xbf08f59b,0xbea09ae5,0xbf5064af,0xbf239da9,0xbed8106b,0xbe354098
.long 0xbf3fc767,0xbf0b9a6b,0xbe9aa086,0xbd16c32c,0xbf2d1469,0xbee363fa,0xbe354098,0x3dd53db9
.long 0xbf187fc0,0xbeac7cd4,0xbd48fb30,0x3e78cfcc,0xbf0242b1,0xbe667c66,0x3da3308c,0x3ec1071e
.long 0xbed53641,0xbde1bc2e,0x3e541501,0x3f00e7e4,0xbea395c5,0x3bc90f88,0x3ea986c4,0x3f1ebc12
.long 0xbe605c13,0x3dfab273,0x3ee63375,0x3f396842,0xbdee3876,0x3e72b651,0x3f0f8784,0x3f5064af
.long 0xbc490e90,0x3eb263ef,0x3f299415,0x3f633c5a,0x3dbc3ac3,0x3ee900b7,0x3f40d0da,0x3f718f57
.long 0xbf226799,0xbef15aea,0xbe94a031,0xbdc8bd36,0xbf0242b1,0xbea395c5,0xbdee3876,0x3dbc3ac3
.long 0xbebe1d4a,0xbe22abb6,0x3d7b2b74,0x3e8e9a22,0xbe667c66,0x3bc90f88,0x3e72b651,0x3ee900b7
.long 0xbd96a905,0x3e2f10a2,0x3ecf7bca,0x3f1d7fd1,0x3da3308c,0x3ea986c4,0x3f0f8784,0x3f40d0da
.long 0x3e6c9a7f,0x3ef6e0cb,0x3f32c8c9,0x3f5d2d53,0x3ec1071e,0x3f1ebc12,0x3f5064af,0x3f718f57
.long 0x3f039c3d,0x3f3daef9,0x3f676bd8,0x3f7d3aac,0x3f239da9,0x3f577026,0x3f772417,0x3f7fc38f
.long 0x3f3fc767,0x3f6b4b0c,0x3f7f0e58,0x3f791298,0x3f577026,0x3f78b47b,0x3f7eea9d,0x3f696591
.long 0x3f6a09a7,0x3f7f4e6d,0x3f76ba07,0x3f514d3d,0x3f772417,0x3f7eea9d,0x3f66becc,0x3f31a81d
.long 0x3f7e70b0,0x3f778bc5,0x3f4f7a1f,0x3f0b9a6b,0x3f7fc38f,0x3f696591,0x3f31a81d,0x3ec1071e
.long 0x3c00,0x3c00,0x3c00,0x3c00,0x3c00,0x361f3b64,0x39a839a8,0x3b64361f
.long 0x3c00,0x39a839a8,0x3c000000,0x39a8b9a8,0x3c00,0x3b64361f,0x39a8b9a8,0xb61fbb64
.long 0x3c00,0x3c000000,0xbc00,0xbc000000,0x3c00,0x3b64b61f,0xb9a8b9a8,0xb61f3b64
.long 0x3c00,0x39a8b9a8,0xbc000000,0x39a839a8,0x3c00,0x361fbb64,0xb9a839a8,0x3b64b61f
.long 0x3c00,0xbc00,0x3c00,0xbc00,0x3c00,0xb61fbb64,0x39a839a8,0xbb64b61f
.long 0x3c00,0xb9a8b9a8,0x3c000000,0xb9a839a8,0x3c00,0xbb64b61f,0x39a8b9a8,0x361f3b64
.long 0x3c00,0xbc000000,0xbc00,0x3c000000,0x3c00,0xbb64361f,0xb9a8b9a8,0x361fbb64
.long 0x3c00,0xb9a839a8,0xbc000000,0xb9a8b9a8,0x3c00,0xb61f3b64,0xb9a839a8,0xbb64361f
.long 0x3c00,0x3c00,0x3c00,0x3c00,0x3c000000,0x3b64b61f,0x39a8b9a8,0x361fbb64
.long 0xbc00,0xb9a8b9a8,0xbc000000,0xb9a839a8,0xbc000000,0xb61f3b64,0x39a839a8,0x3b64b61f
.long 0x3c00,0x3c000000,0xbc00,0xbc000000,0x3c000000,0xb61fbb64,0xb9a839a8,0x3b64361f
.long 0xbc00,0xb9a839a8,0x3c000000,0xb9a8b9a8,0xbc000000,0x3b64361f,0xb9a8b9a8,0x361f3b64
.long 0x3c00,0xbc00,0x3c00,0xbc00,0x3c000000,0xbb64361f,0x39a8b9a8,0xb61f3b64
.long 0xbc00,0x39a839a8,0xbc000000,0x39a8b9a8,0xbc000000,0x361fbb64,0x39a839a8,0xbb64361f
.long 0x3c00,0xbc000000,0xbc00,0x3c000000,0x3c000000,0x361f3b64,0xb9a839a8,0xbb64b61f
.long 0xbc00,0x39a8b9a8,0x3c000000,0x39a839a8,0xbc000000,0xbb64b61f,0xb9a8b9a8,0xb61fbb64
.long 0x3c00,0x3c00,0x3c00,0x3c00,0xbc00,0xb61fbb64,0xb9a8b9a8,0xbb64b61f
.long 0x3c00,0x39a839a8,0x3c000000,0x39a8b9a8,0xbc00,0xbb64b61f,0xb9a839a8,0x361f3b64
.long 0x3c00,0x3c000000,0xbc00,0xbc000000,0xbc00,0xbb64361f,0x39a839a8,0x361fbb64
.long 0x3c00,0x39a8b9a8,0xbc000000,0x39a839a8,0xbc00,0xb61f3b64,0x39a8b9a8,0xbb64361f
.long 0x3c00,0xbc00,0x3c00,0xbc00,0xbc00,0x361f3b64,0xb9a8b9a8,0x3b64361f
.long 0x3c00,0xb9a8b9a8,0x3c000000,0xb9a839a8,0xbc00,0x3b64361f,0xb9a839a8,0xb61fbb64
.long 0x3c00,0xbc000000,0xbc00,0x3c000000,0xbc00,0x3b64b61f,0x39a839a8,0xb61f3b64
.long 0x3c00,0xb9a839a8,0xbc000000,0xb9a8b9a8,0xbc00,0x361fbb64,0x39a8b9a8,0x3b64b61f
.long 0x3c00,0x3c00,0x3c00,0x3c00,0xbc000000,0xbb64361f,0xb9a839a8,0xb61f3b64
.long 0xbc00,0xb9a8b9a8,0xbc000000,0xb9a839a8,0x3c000000,0x361fbb64,0xb9a8b9a8,0xbb64361f
.long 0x3c00,0x3c000000,0xbc00,0xbc000000,0xbc000000,0x361f3b64,0x39a8b9a8,0xbb64b61f
.long 0xbc00,0xb9a839a8,0x3c000000,0xb9a8b9a8,0x3c000000,0xbb64b61f,0x39a839a8,0xb61fbb64
.long 0x3c00,0xbc00,0x3c00,0xbc00,0xbc000000,0x3b64b61f,0xb9a839a8,0x361fbb64
.long 0xbc00,0x39a839a8,0xbc000000,0x39a8b9a8,0x3c000000,0xb61f3b64,0xb9a8b9a8,0x3b64b61f
.long 0x3c00,0xbc000000,0xbc00,0x3c000000,0xbc000000,0xb61fbb64,0x39a8b9a8,0x3b64361f
.long 0xbc00,0x39a8b9a8,0x3c000000,0x39a839a8,0x3c000000,0x3b64361f,0x39a839a8,0x361f3b64
.long 0x3c008000,0x3c008000,0x3c008000,0x3c008000,0x3c008000,0x3b64b61f,0x39a8b9a8,0x361fbb64
.long 0x3c008000,0x39a8b9a8,0xbc00,0xb9a8b9a8,0x3c008000,0x361fbb64,0xb9a8b9a8,0xbb64361f
.long 0x3c008000,0xbc00,0xbc008000,0x3c00,0x3c008000,0xb61fbb64,0xb9a839a8,0x3b64361f
.long 0x3c008000,0xb9a8b9a8,0x3c00,0x39a8b9a8,0x3c008000,0xbb64b61f,0x39a839a8,0xb61fbb64
.long 0x3c008000,0xbc008000,0x3c008000,0xbc008000,0x3c008000,0xbb64361f,0x39a8b9a8,0xb61f3b64
.long 0x3c008000,0xb9a839a8,0xbc00,0x39a839a8,0x3c008000,0xb61f3b64,0xb9a8b9a8,0x3b64b61f
.long 0x3c008000,0x3c00,0xbc008000,0xbc00,0x3c008000,0x361f3b64,0xb9a839a8,0xbb64b61f
.long 0x3c008000,0x39a839a8,0x3c00,0xb9a839a8,0x3c008000,0x3b64361f,0x39a839a8,0x361f3b64
.long 0x3c008000,0x3c008000,0x3c008000,0x3c008000,0xbc00,0xb61fbb64,0xb9a8b9a8,0xbb64b61f
.long 0xbc008000,0xb9a839a8,0x3c00,0x39a839a8,0x3c00,0x3b64361f,0x39a8b9a8,0xb61fbb64
.long 0x3c008000,0xbc00,0xbc008000,0x3c00,0xbc00,0xbb64361f,0x39a839a8,0x361fbb64
.long 0xbc008000,0x39a839a8,0xbc00,0xb9a839a8,0x3c00,0x361fbb64,0xb9a839a8,0x3b64b61f
.long 0x3c008000,0xbc008000,0x3c008000,0xbc008000,0xbc00,0x361f3b64,0xb9a8b9a8,0x3b64361f
.long 0xbc008000,0x39a8b9a8,0x3c00,0xb9a8b9a8,0x3c00,0xbb64b61f,0x39a8b9a8,0x361f3b64
.long 0x3c008000,0x3c00,0xbc008000,0xbc00,0xbc00,0x3b64b61f,0x39a839a8,0xb61f3b64
.long 0xbc008000,0xb9a8b9a8,0xbc00,0x39a8b9a8,0x3c00,0xb61f3b64,0xb9a839a8,0xbb64361f
.long 0x3c008000,0x3c008000,0x3c008000,0x3c008000,0xbc008000,0xbb64361f,0xb9a839a8,0xb61f3b64
.long 0x3c008000,0x39a8b9a8,0xbc00,0xb9a8b9a8,0xbc008000,0xb61f3b64,0x39a839a8,0x3b64b61f
.long 0x3c008000,0xbc00,0xbc008000,0x3c00,0xbc008000,0x361f3b64,0x39a8b9a8,0xbb64b61f
.long 0x3c008000,0xb9a8b9a8,0x3c00,0x39a8b9a8,0xbc008000,0x3b64361f,0xb9a8b9a8,0x361f3b64
.long 0x3c008000,0xbc008000,0x3c008000,0xbc008000,0xbc008000,0x3b64b61f,0xb9a839a8,0x361fbb64
.long 0x3c008000,0xb9a839a8,0xbc00,0x39a839a8,0xbc008000,0x361fbb64,0x39a839a8,0xbb64361f
.long 0x3c008000,0x3c00,0xbc008000,0xbc00,0xbc008000,0xb61fbb64,0x39a8b9a8,0x3b64361f
.long 0x3c008000,0x39a839a8,0x3c00,0xb9a839a8,0xbc008000,0xbb64b61f,0xb9a8b9a8,0xb61fbb64
.long 0x3c008000,0x3c008000,0x3c008000,0x3c008000,0x3c00,0x361f3b64,0x39a839a8,0x3b64361f
.long 0xbc008000,0xb9a839a8,0x3c00,0x39a839a8,0xbc00,0xbb64b61f,0xb9a839a8,0x361f3b64
.long 0x3c008000,0xbc00,0xbc008000,0x3c00,0x3c00,0x3b64b61f,0xb9a8b9a8,0xb61f3b64
.long 0xbc008000,0x39a839a8,0xbc00,0xb9a839a8,0xbc00,0xb61f3b64,0x39a8b9a8,0xbb64361f
.long 0x3c008000,0xbc008000,0x3c008000,0xbc008000,0x3c00,0xb61fbb64,0x39a839a8,0xbb64b61f
.long 0xbc008000,0x39a8b9a8,0x3c00,0xb9a8b9a8,0xbc00,0x3b64361f,0xb9a839a8,0xb61fbb64
.long 0x3c008000,0x3c00,0xbc008000,0xbc00,0x3c00,0xbb64361f,0xb9a8b9a8,0x361fbb64
.long 0xbc008000,0xb9a8b9a8,0xbc00,0x39a8b9a8,0xbc00,0x361fbb64,0x39a8b9a8,0x3b64b61f
.long 0x3c00,0x3c00,0x3c00,0x3c00,0x323e3bd9,0x38723aa7,0x3aa73872,0x3bd9323e
.long 0x361f3b64,0x3b64361f,0x3b64b61f,0x361fbb64,0x38723aa7,0x3bd9b23e,0x323ebbd9,0xbaa7b872
.long 0x39a839a8,0x39a8b9a8,0xb9a8b9a8,0xb9a839a8,0x3aa73872,0x323ebbd9,0xbbd9323e,0x38723aa7
.long 0x3b64361f,0xb61fbb64,0xb61f3b64,0x3b64b61f,0x3bd9323e,0xbaa7b872,0x38723aa7,0xb23ebbd9
.long 0x3c000000,0xbc000000,0x3c000000,0xbc000000,0x3bd9b23e,0xbaa73872,0x3872baa7,0xb23e3bd9
.long 0x3b64b61f,0xb61f3b64,0xb61fbb64,0x3b64361f,0x3aa7b872,0x323e3bd9,0xbbd9b23e,0x3872baa7
.long 0x39a8b9a8,0x39a839a8,0xb9a839a8,0xb9a8b9a8,0x3872baa7,0x3bd9323e,0x323e3bd9,0xbaa73872
.long 0x361fbb64,0x3b64b61f,0x3b64361f,0x361f3b64,0x323ebbd9,0x3872baa7,0x3aa7b872,0x3bd9b23e
.long 0x3c00,0x3c00,0x3c00,0x3c00,0x3bd9b23e,0x3aa7b872,0x3872baa7,0x323ebbd9
.long 0xb61fbb64,0xbb64b61f,0xbb64361f,0xb61f3b64,0xbaa73872,0x323e3bd9,0x3bd9323e,0x3872baa7
.long 0x39a839a8,0x39a8b9a8,0xb9a8b9a8,0xb9a839a8,0x3872baa7,0xbbd9b23e,0x323e3bd9,0x3aa7b872
.long 0xbb64b61f,0x361f3b64,0x361fbb64,0xbb64361f,0xb23e3bd9,0x3872baa7,0xbaa73872,0x3bd9b23e
.long 0x3c000000,0xbc000000,0x3c000000,0xbc000000,0xb23ebbd9,0x38723aa7,0xbaa7b872,0x3bd9323e
.long 0xbb64361f,0x361fbb64,0x361f3b64,0xbb64b61f,0x38723aa7,0xbbd9323e,0x323ebbd9,0x3aa73872
.long 0x39a8b9a8,0x39a839a8,0xb9a839a8,0xb9a8b9a8,0xbaa7b872,0x323ebbd9,0x3bd9b23e,0x38723aa7
.long 0xb61f3b64,0xbb64361f,0xbb64b61f,0xb61fbb64,0x3bd9323e,0x3aa73872,0x38723aa7,0x323e3bd9
.long 0x3c00,0x3c00,0x3c00,0x3c00,0xb23ebbd9,0xb872baa7,0xbaa7b872,0xbbd9b23e
.long 0x361f3b64,0x3b64361f,0x3b64b61f,0x361fbb64,0xb872baa7,0xbbd9323e,0xb23e3bd9,0x3aa73872
.long 0x39a839a8,0x39a8b9a8,0xb9a8b9a8,0xb9a839a8,0xbaa7b872,0xb23e3bd9,0x3bd9b23e,0xb872baa7
.long 0x3b64361f,0xb61fbb64,0xb61f3b64,0x3b64b61f,0xbbd9b23e,0x3aa73872,0xb872baa7,0x323e3bd9
.long 0x3c000000,0xbc000000,0x3c000000,0xbc000000,0xbbd9323e,0x3aa7b872,0xb8723aa7,0x323ebbd9
.long 0x3b64b61f,0xb61f3b64,0xb61fbb64,0x3b64361f,0xbaa73872,0xb23ebbd9,0x3bd9323e,0xb8723aa7
.long 0x39a8b9a8,0x39a839a8,0xb9a839a8,0xb9a8b9a8,0xb8723aa7,0xbbd9b23e,0xb23ebbd9,0x3aa7b872
.long 0x361fbb64,0x3b64b61f,0x3b64361f,0x361f3b64,0xb23e3bd9,0xb8723aa7,0xbaa73872,0xbbd9323e
.long 0x3c00,0x3c00,0x3c00,0x3c00,0xbbd9323e,0xbaa73872,0xb8723aa7,0xb23e3bd9
.long 0xb61fbb64,0xbb64b61f,0xbb64361f,0xb61f3b64,0x3aa7b872,0xb23ebbd9,0xbbd9b23e,0xb8723aa7
.long 0x39a839a8,0x39a8b9a8,0xb9a8b9a8,0xb9a839a8,0xb8723aa7,0x3bd9323e,0xb23ebbd9,0xbaa73872
.long 0xbb64b61f,0x361f3b64,0x361fbb64,0xbb64361f,0x323ebbd9,0xb8723aa7,0x3aa7b872,0xbbd9323e
.long 0x3c000000,0xbc000000,0x3c000000,0xbc000000,0x323e3bd9,0xb872baa7,0x3aa73872,0xbbd9b23e
.long 0xbb64361f,0x361fbb64,0x361f3b64,0xbb64b61f,0xb872baa7,0x3bd9b23e,0xb23e3bd9,0xbaa7b872
.long 0x39a8b9a8,0x39a839a8,0xb9a839a8,0xb9a8b9a8,0x3aa73872,0xb23e3bd9,0xbbd9323e,0xb872baa7
.long 0xb61f3b64,0xbb64361f,0xbb64b61f,0xb61fbb64,0xbbd9b23e,0xbaa7b872,0xb872baa7,0xb23ebbd9
.long 0x3c008000,0x3c008000,0x3c008000,0x3c008000,0x3bd9b23e,0x3aa7b872,0x3872baa7,0x323ebbd9
.long 0x3b64b61f,0x361fbb64,0xb61fbb64,0xbb64b61f,0x3aa7b872,0xb23ebbd9,0xbbd9b23e,0xb8723aa7
.long 0x39a8b9a8,0xb9a8b9a8,0xb9a839a8,0x39a839a8,0x3872baa7,0xbbd9b23e,0x323e3bd9,0x3aa7b872
.long 0x361fbb64,0xbb64361f,0x3b64361f,0xb61fbb64,0x323ebbd9,0xb8723aa7,0x3aa7b872,0xbbd9323e
.long 0xbc00,0x3c00,0xbc00,0x3c00,0xb23ebbd9,0x38723aa7,0xbaa7b872,0x3bd9323e
.long 0xb61fbb64,0x3b64361f,0xbb64361f,0x361fbb64,0xb872baa7,0x3bd9b23e,0xb23e3bd9,0xbaa7b872
.long 0xb9a8b9a8,0x39a8b9a8,0x39a839a8,0xb9a839a8,0xbaa7b872,0x323ebbd9,0x3bd9b23e,0x38723aa7
.long 0xbb64b61f,0xb61fbb64,0x361fbb64,0x3b64b61f,0xbbd9b23e,0xbaa7b872,0xb872baa7,0xb23ebbd9
.long 0x3c008000,0x3c008000,0x3c008000,0x3c008000,0xb23ebbd9,0xb872baa7,0xbaa7b872,0xbbd9b23e
.long 0xbb64361f,0xb61f3b64,0x361f3b64,0x3b64361f,0x38723aa7,0x3bd9b23e,0x323ebbd9,0xbaa7b872
.long 0x39a8b9a8,0xb9a8b9a8,0xb9a839a8,0x39a839a8,0xbaa7b872,0xb23e3bd9,0x3bd9b23e,0xb872baa7
.long 0xb61f3b64,0x3b64b61f,0xbb64b61f,0x361f3b64,0x3bd9323e,0xbaa7b872,0x38723aa7,0xb23ebbd9
.long 0xbc00,0x3c00,0xbc00,0x3c00,0xbbd9323e,0x3aa7b872,0xb8723aa7,0x323ebbd9
.long 0x361f3b64,0xbb64b61f,0x3b64b61f,0xb61f3b64,0x3aa7b872,0x323e3bd9,0xbbd9b23e,0x3872baa7
.long 0xb9a8b9a8,0x39a8b9a8,0x39a839a8,0xb9a839a8,0xb8723aa7,0xbbd9b23e,0xb23ebbd9,0x3aa7b872
.long 0x3b64361f,0x361f3b64,0xb61f3b64,0xbb64361f,0x323ebbd9,0x3872baa7,0x3aa7b872,0x3bd9b23e
.long 0x3c008000,0x3c008000,0x3c008000,0x3c008000,0xbbd9323e,0xbaa73872,0xb8723aa7,0xb23e3bd9
.long 0x3b64b61f,0x361fbb64,0xb61fbb64,0xbb64b61f,0xbaa73872,0x323e3bd9,0x3bd9323e,0x3872baa7
.long 0x39a8b9a8,0xb9a8b9a8,0xb9a839a8,0x39a839a8,0xb8723aa7,0x3bd9323e,0xb23ebbd9,0xbaa73872
.long 0x361fbb64,0xbb64361f,0x3b64361f,0xb61fbb64,0xb23e3bd9,0x3872baa7,0xbaa73872,0x3bd9b23e
.long 0xbc00,0x3c00,0xbc00,0x3c00,0x323e3bd9,0xb872baa7,0x3aa73872,0xbbd9b23e
.long 0xb61fbb64,0x3b64361f,0xbb64361f,0x361fbb64,0x38723aa7,0xbbd9323e,0x323ebbd9,0x3aa73872
.long 0xb9a8b9a8,0x39a8b9a8,0x39a839a8,0xb9a839a8,0x3aa73872,0xb23e3bd9,0xbbd9323e,0xb872baa7
.long 0xbb64b61f,0xb61fbb64,0x361fbb64,0x3b64b61f,0x3bd9323e,0x3aa73872,0x38723aa7,0x323e3bd9
.long 0x3c008000,0x3c008000,0x3c008000,0x3c008000,0x323e3bd9,0x38723aa7,0x3aa73872,0x3bd9323e
.long 0xbb64361f,0xb61f3b64,0x361f3b64,0x3b64361f,0xb872baa7,0xbbd9323e,0xb23e3bd9,0x3aa73872
.long 0x39a8b9a8,0xb9a8b9a8,0xb9a839a8,0x39a839a8,0x3aa73872,0x323ebbd9,0xbbd9323e,0x38723aa7
.long 0xb61f3b64,0x3b64b61f,0xbb64b61f,0x361f3b64,0xbbd9b23e,0x3aa73872,0xb872baa7,0x323e3bd9
.long 0xbc00,0x3c00,0xbc00,0x3c00,0x3bd9b23e,0xbaa73872,0x3872baa7,0xb23e3bd9
.long 0x361f3b64,0xbb64b61f,0x3b64b61f,0xb61f3b64,0xbaa73872,0xb23ebbd9,0x3bd9323e,0xb8723aa7
.long 0xb9a8b9a8,0x39a8b9a8,0x39a839a8,0xb9a839a8,0x3872baa7,0x3bd9323e,0x323e3bd9,0xbaa73872
.long 0x3b64361f,0x361f3b64,0xb61f3b64,0xbb64361f,0xb23e3bd9,0xb8723aa7,0xbaa73872,0xbbd9323e
.size tab1, 16384
.p2align 8
.type tab3,@object
tab3:
.long 0x80003c00,0x80003c00,0x80003c00,0x80003c00,0x80003c00,0xb61f3b64,0xb9a839a8,0xbb64361f
.long 0x80003c00,0xb9a839a8,0xbc000000,0xb9a8b9a8,0x80003c00,0xbb64361f,0xb9a8b9a8,0x361fbb64
.long 0x80003c00,0xbc000000,0x8000bc00,0x3c000000,0x80003c00,0xbb64b61f,0x39a8b9a8,0x361f3b64
.long 0x80003c00,0xb9a8b9a8,0x3c000000,0xb9a839a8,0x80003c00,0xb61fbb64,0x39a839a8,0xbb64b61f
.long 0x80003c00,0x8000bc00,0x80003c00,0x8000bc00,0x80003c00,0x361fbb64,0xb9a839a8,0x3b64b61f
.long 0x80003c00,0x39a8b9a8,0xbc000000,0x39a839a8,0x80003c00,0x3b64b61f,0xb9a8b9a8,0xb61f3b64
.long 0x80003c00,0x3c000000,0x8000bc00,0xbc000000,0x80003c00,0x3b64361f,0x39a8b9a8,0xb61fbb64
.long 0x80003c00,0x39a839a8,0x3c000000,0x39a8b9a8,0x80003c00,0x361f3b64,0x39a839a8,0x3b64361f
.long 0x80003c00,0x80003c00,0x80003c00,0x80003c00,0xbc000000,0xbb64b61f,0xb9a8b9a8,0xb61fbb64
.long 0x8000bc00,0x39a8b9a8,0x3c000000,0x39a839a8,0x3c000000,0x361f3b64,0xb9a839a8,0xbb64b61f
.long 0x80003c00,0xbc000000,0x8000bc00,0x3c000000,0xbc000000,0x361fbb64,0x39a839a8,0xbb64361f
.long 0x8000bc00,0x39a839a8,0xbc000000,0x39a8b9a8,0x3c000000,0xbb64361f,0x39a8b9a8,0xb61f3b64
.long 0x80003c00,0x8000bc00,0x80003c00,0x8000bc00,0xbc000000,0x3b64361f,0xb9a8b9a8,0x361f3b64
.long 0x8000bc00,0xb9a839a8,0x3c000000,0xb9a8b9a8,0x3c000000,0xb61fbb64,0xb9a839a8,0x3b64361f
.long 0x80003c00,0x3c000000,0x8000bc00,0xbc000000,0xbc000000,0xb61f3b64,0x39a839a8,0x3b64b61f
.long 0x8000bc00,0xb9a8b9a8,0xbc000000,0xb9a839a8,0x3c000000,0x3b64b61f,0x39a8b9a8,0x361fbb64
.long 0x80003c00,0x80003c00,0x80003c00,0x80003c00,0x8000bc00,0x361fbb64,0x39a8b9a8,0x3b64b61f
.long 0x80003c00,0xb9a839a8,0xbc000000,0xb9a8b9a8,0x8000bc00,0x3b64b61f,0x39a839a8,0xb61f3b64
.long 0x80003c00,0xbc000000,0x8000bc00,0x3c000000,0x8000bc00,0x3b64361f,0xb9a839a8,0xb61fbb64
.long 0x80003c00,0xb9a8b9a8,0x3c000000,0xb9a839a8,0x8000bc00,0x361f3b64,0xb9a8b9a8,0x3b64361f
.long 0x80003c00,0x8000bc00,0x80003c00,0x8000bc00,0x8000bc00,0xb61f3b64,0x39a8b9a8,0xbb64361f
.long 0x80003c00,0x39a8b9a8,0xbc000000,0x39a839a8,0x8000bc00,0xbb64361f,0x39a839a8,0x361fbb64
.long 0x80003c00,0x3c000000,0x8000bc00,0xbc000000,0x8000bc00,0xbb64b61f,0xb9a839a8,0x361f3b64
.long 0x80003c00,0x39a839a8,0x3c000000,0x39a8b9a8,0x8000bc00,0xb61fbb64,0xb9a8b9a8,0xbb64b61f
.long 0x80003c00,0x80003c00,0x80003c00,0x80003c00,0x3c000000,0x3b64361f,0x39a839a8,0x361f3b64
.long 0x8000bc00,0x39a8b9a8,0x3c000000,0x39a839a8,0xbc000000,0xb61fbb64,0x39a8b9a8,0x3b64361f
.long 0x80003c00,0xbc000000,0x8000bc00,0x3c000000,0x3c000000,0xb61f3b64,0xb9a8b9a8,0x3b64b61f
.long 0x8000bc00,0x39a839a8,0xbc000000,0x39a8b9a8,0xbc000000,0x3b64b61f,0xb9a839a8,0x361fbb64
.long 0x80003c00,0x8000bc00,0x80003c00,0x8000bc00,0x3c000000,0xbb64b61f,0x39a839a8,0xb61fbb64
.long 0x8000bc00,0xb9a839a8,0x3c000000,0xb9a8b9a8,0xbc000000,0x361f3b64,0x39a8b9a8,0xbb64b61f
.long 0x80003c00,0x3c000000,0x8000bc00,0xbc000000,0x3c000000,0x361fbb64,0xb9a8b9a8,0xbb64361f
.long 0x8000bc00,0xb9a8b9a8,0xbc000000,0xb9a839a8,0xbc000000,0xbb64361f,0xb9a839a8,0xb61f3b64
.long 0x3c000000,0x3c000000,0x3c000000,0x3c000000,0x3c000000,0x3b64361f,0x39a839a8,0x361f3b64
.long 0x3c000000,0x39a839a8,0x3c00,0xb9a839a8,0x3c000000,0x361f3b64,0xb9a839a8,0xbb64b61f
.long 0x3c000000,0x3c00,0xbc000000,0xbc00,0x3c000000,0xb61f3b64,0xb9a8b9a8,0x3b64b61f
.long 0x3c000000,0xb9a839a8,0xbc00,0x39a839a8,0x3c000000,0xbb64361f,0x39a8b9a8,0xb61f3b64
.long 0x3c000000,0xbc000000,0x3c000000,0xbc000000,0x3c000000,0xbb64b61f,0x39a839a8,0xb61fbb64
.long 0x3c000000,0xb9a8b9a8,0x3c00,0x39a8b9a8,0x3c000000,0xb61fbb64,0xb9a839a8,0x3b64361f
.long 0x3c000000,0xbc00,0xbc000000,0x3c00,0x3c000000,0x361fbb64,0xb9a8b9a8,0xbb64361f
.long 0x3c000000,0x39a8b9a8,0xbc00,0xb9a8b9a8,0x3c000000,0x3b64b61f,0x39a8b9a8,0x361fbb64
.long 0x3c000000,0x3c000000,0x3c000000,0x3c000000,0x3c00,0xb61f3b64,0xb9a839a8,0xbb64361f
.long 0xbc000000,0xb9a8b9a8,0xbc00,0x39a8b9a8,0xbc00,0x3b64b61f,0x39a839a8,0xb61f3b64
.long 0x3c000000,0x3c00,0xbc000000,0xbc00,0x3c00,0xbb64b61f,0x39a8b9a8,0x361f3b64
.long 0xbc000000,0x39a8b9a8,0x3c00,0xb9a8b9a8,0xbc00,0x361f3b64,0xb9a8b9a8,0x3b64361f
.long 0x3c000000,0xbc000000,0x3c000000,0xbc000000,0x3c00,0x361fbb64,0xb9a839a8,0x3b64b61f
.long 0xbc000000,0x39a839a8,0xbc00,0xb9a839a8,0xbc00,0xbb64361f,0x39a839a8,0x361fbb64
.long 0x3c000000,0xbc00,0xbc000000,0x3c00,0x3c00,0x3b64361f,0x39a8b9a8,0xb61fbb64
.long 0xbc000000,0xb9a839a8,0x3c00,0x39a839a8,0xbc00,0xb61fbb64,0xb9a8b9a8,0xbb64b61f
.long 0x3c000000,0x3c000000,0x3c000000,0x3c000000,0xbc000000,0xbb64b61f,0xb9a8b9a8,0xb61fbb64
.long 0x3c000000,0x39a839a8,0x3c00,0xb9a839a8,0xbc000000,0xb61fbb64,0x39a8b9a8,0x3b64361f
.long 0x3c000000,0x3c00,0xbc000000,0xbc00,0xbc000000,0x361fbb64,0x39a839a8,0xbb64361f
.long 0x3c000000,0xb9a839a8,0xbc00,0x39a839a8,0xbc000000,0x3b64b61f,0xb9a839a8,0x361fbb64
.long 0x3c000000,0xbc000000,0x3c000000,0xbc000000,0xbc000000,0x3b64361f,0xb9a8b9a8,0x361f3b64
.long 0x3c000000,0xb9a8b9a8,0x3c00,0x39a8b9a8,0xbc000000,0x361f3b64,0x39a8b9a8,0xbb64b61f
.long 0x3c000000,0xbc00,0xbc000000,0x3c00,0xbc000000,0xb61f3b64,0x39a839a8,0x3b64b61f
.long 0x3c000000,0x39a8b9a8,0xbc00,0xb9a8b9a8,0xbc000000,0xbb64361f,0xb9a839a8,0xb61f3b64
.long 0x3c000000,0x3c000000,0x3c000000,0x3c000000,0xbc00,0x361fbb64,0x39a8b9a8,0x3b64b61f
.long 0xbc000000,0xb9a8b9a8,0xbc00,0x39a8b9a8,0x3c00,0xbb64361f,0xb9a8b9a8,0x361fbb64
.long 0x3c000000,0x3c00,0xbc000000,0xbc00,0xbc00,0x3b64361f,0xb9a839a8,0xb61fbb64
.long 0xbc000000,0x39a8b9a8,0x3c00,0xb9a8b9a8,0x3c00,0xb61fbb64,0x39a839a8,0xbb64b61f
.long 0x3c000000,0xbc000000,0x3c000000,0xbc000000,0xbc00,0xb61f3b64,0x39a8b9a8,0xbb64361f
.long 0xbc000000,0x39a839a8,0xbc00,0xb9a839a8,0x3c00,0x3b64b61f,0xb9a8b9a8,0xb61f3b64
.long 0x3c000000,0xbc00,0xbc000000,0x3c00,0xbc00,0xbb64b61f,0xb9a839a8,0x361f3b64
.long 0xbc000000,0xb9a839a8,0x3c00,0x39a839a8,0x3c00,0x361f3b64,0x39a839a8,0x3b64361f
.long 0x80003c00,0xb23e3bd9,0xb61f3b64,0xb8723aa7,0x80003c00,0xb8723aa7,0xbb64361f,0xbbd9b23e
.long 0x80003c00,0xbaa73872,0xbb64b61f,0xb23ebbd9,0x80003c00,0xbbd9323e,0xb61fbb64,0x3aa7b872
.long 0x80003c00,0xbbd9b23e,0x361fbb64,0x3aa73872,0x80003c00,0xbaa7b872,0x3b64b61f,0xb23e3bd9
.long 0x80003c00,0xb872baa7,0x3b64361f,0xbbd9323e,0x80003c00,0xb23ebbd9,0x361f3b64,0xb872baa7
.long 0x80003c00,0x323ebbd9,0xb61f3b64,0x3872baa7,0x80003c00,0x3872baa7,0xbb64361f,0x3bd9323e
.long 0x80003c00,0x3aa7b872,0xbb64b61f,0x323e3bd9,0x80003c00,0x3bd9b23e,0xb61fbb64,0xbaa73872
.long 0x80003c00,0x3bd9323e,0x361fbb64,0xbaa7b872,0x80003c00,0x3aa73872,0x3b64b61f,0x323ebbd9
.long 0x80003c00,0x38723aa7,0x3b64361f,0x3bd9b23e,0x80003c00,0x323e3bd9,0x361f3b64,0x38723aa7
.long 0xb9a839a8,0xbaa73872,0xbb64361f,0xbbd9323e,0xb9a8b9a8,0xb23ebbd9,0x361fbb64,0x3aa7b872
.long 0x39a8b9a8,0x3bd9323e,0x361f3b64,0xb8723aa7,0x39a839a8,0xb8723aa7,0xbb64b61f,0x323ebbd9
.long 0xb9a839a8,0xb872baa7,0x3b64b61f,0x323e3bd9,0xb9a8b9a8,0x3bd9b23e,0xb61f3b64,0xb872baa7
.long 0x39a8b9a8,0xb23e3bd9,0xb61fbb64,0x3aa73872,0x39a839a8,0xbaa7b872,0x3b64361f,0xbbd9b23e
.long 0xb9a839a8,0x3aa7b872,0xbb64361f,0x3bd9b23e,0xb9a8b9a8,0x323e3bd9,0x361fbb64,0xbaa73872
.long 0x39a8b9a8,0xbbd9b23e,0x361f3b64,0x3872baa7,0x39a839a8,0x3872baa7,0xbb64b61f,0xb23e3bd9
.long 0xb9a839a8,0x38723aa7,0x3b64b61f,0xb23ebbd9,0xb9a8b9a8,0xbbd9323e,0xb61f3b64,0x38723aa7
.long 0x39a8b9a8,0x323ebbd9,0xb61fbb64,0xbaa7b872,0x39a839a8,0x3aa73872,0x3b64361f,0x3bd9323e
.long 0xbc000000,0xbbd9b23e,0xbb64b61f,0xbaa7b872,0x3c000000,0x3aa73872,0x361f3b64,0xb23e3bd9
.long 0xbc000000,0xb872baa7,0x361fbb64,0x3bd9b23e,0x3c000000,0x323e3bd9,0xbb64361f,0xb872baa7
.long 0xbc000000,0x323ebbd9,0x3b64361f,0xb8723aa7,0x3c000000,0xb8723aa7,0xb61fbb64,0x3bd9323e
.long 0xbc000000,0x3aa7b872,0xb61f3b64,0xb23ebbd9,0x3c000000,0xbbd9323e,0x3b64b61f,0xbaa73872
.long 0xbc000000,0x3bd9323e,0xbb64b61f,0x3aa73872,0x3c000000,0xbaa7b872,0x361f3b64,0x323ebbd9
.long 0xbc000000,0x38723aa7,0x361fbb64,0xbbd9323e,0x3c000000,0xb23ebbd9,0xbb64361f,0x38723aa7
.long 0xbc000000,0xb23e3bd9,0x3b64361f,0x3872baa7,0x3c000000,0x3872baa7,0xb61fbb64,0xbbd9b23e
.long 0xbc000000,0xbaa73872,0xb61f3b64,0x323e3bd9,0x3c000000,0x3bd9b23e,0x3b64b61f,0x3aa7b872
.long 0xb9a8b9a8,0xb872baa7,0xb61fbb64,0xb23ebbd9,0xb9a839a8,0xbbd9323e,0xbb64b61f,0xb872baa7
.long 0x39a839a8,0xb23e3bd9,0xbb64361f,0xbaa7b872,0x39a8b9a8,0x3aa73872,0xb61f3b64,0xbbd9b23e
.long 0xb9a8b9a8,0x3aa7b872,0x361f3b64,0xbbd9323e,0xb9a839a8,0xb23ebbd9,0x3b64361f,0xbaa73872
.long 0x39a839a8,0xbbd9b23e,0x3b64b61f,0xb8723aa7,0x39a8b9a8,0xb8723aa7,0x361fbb64,0xb23e3bd9
.long 0xb9a8b9a8,0x38723aa7,0xb61fbb64,0x323e3bd9,0xb9a839a8,0x3bd9b23e,0xbb64b61f,0x38723aa7
.long 0x39a839a8,0x323ebbd9,0xbb64361f,0x3aa73872,0x39a8b9a8,0xbaa7b872,0xb61f3b64,0x3bd9323e
.long 0xb9a8b9a8,0xbaa73872,0x361f3b64,0x3bd9b23e,0xb9a839a8,0x323e3bd9,0x3b64361f,0x3aa7b872
.long 0x39a839a8,0x3bd9323e,0x3b64b61f,0x3872baa7,0x39a8b9a8,0x3872baa7,0x361fbb64,0x323ebbd9
.long 0x3c000000,0x3bd9323e,0x3b64361f,0x3aa73872,0x3c000000,0x3aa73872,0x361f3b64,0xb23e3bd9
.long 0x3c000000,0x38723aa7,0xb61f3b64,0xbbd9323e,0x3c000000,0x323e3bd9,0xbb64361f,0xb872baa7
.long 0x3c000000,0xb23e3bd9,0xbb64b61f,0x3872baa7,0x3c000000,0xb8723aa7,0xb61fbb64,0x3bd9323e
.long 0x3c000000,0xbaa73872,0x361fbb64,0x323e3bd9,0x3c000000,0xbbd9323e,0x3b64b61f,0xbaa73872
.long 0x3c000000,0xbbd9b23e,0x3b64361f,0xbaa7b872,0x3c000000,0xbaa7b872,0x361f3b64,0x323ebbd9
.long 0x3c000000,0xb872baa7,0xb61f3b64,0x3bd9b23e,0x3c000000,0xb23ebbd9,0xbb64361f,0x38723aa7
.long 0x3c000000,0x323ebbd9,0xbb64b61f,0xb8723aa7,0x3c000000,0x3872baa7,0xb61fbb64,0xbbd9b23e
.long 0x3c000000,0x3aa7b872,0x361fbb64,0xb23ebbd9,0x3c000000,0x3bd9b23e,0x3b64b61f,0x3aa7b872
.long 0x39a839a8,0x38723aa7,0x361f3b64,0x323e3bd9,0xb9a839a8,0xbbd9323e,0xbb64b61f,0xb872baa7
.long 0xb9a8b9a8,0x323ebbd9,0x3b64b61f,0x3aa73872,0x39a8b9a8,0x3aa73872,0xb61f3b64,0xbbd9b23e
.long 0x39a839a8,0xbaa73872,0xb61fbb64,0x3bd9b23e,0xb9a839a8,0xb23ebbd9,0x3b64361f,0xbaa73872
.long 0xb9a8b9a8,0x3bd9323e,0xbb64361f,0x3872baa7,0x39a8b9a8,0xb8723aa7,0x361fbb64,0xb23e3bd9
.long 0x39a839a8,0xb872baa7,0x361f3b64,0xb23ebbd9,0xb9a839a8,0x3bd9b23e,0xbb64b61f,0x38723aa7
.long 0xb9a8b9a8,0xb23e3bd9,0x3b64b61f,0xbaa7b872,0x39a8b9a8,0xbaa7b872,0xb61f3b64,0x3bd9323e
.long 0x39a839a8,0x3aa7b872,0xb61fbb64,0xbbd9323e,0xb9a839a8,0x323e3bd9,0x3b64361f,0x3aa7b872
.long 0xb9a8b9a8,0xbbd9b23e,0xbb64361f,0xb8723aa7,0x39a8b9a8,0x3872baa7,0x361fbb64,0x323ebbd9
.long 0x3c00,0xb23e3bd9,0xb61f3b64,0xb8723aa7,0xbc00,0x3872baa7,0x3b64b61f,0x3bd9323e
.long 0x3c00,0xbaa73872,0xbb64b61f,0xb23ebbd9,0xbc00,0x3bd9b23e,0x361f3b64,0xbaa73872
.long 0x3c00,0xbbd9b23e,0x361fbb64,0x3aa73872,0xbc00,0x3aa73872,0xbb64361f,0x323ebbd9
.long 0x3c00,0xb872baa7,0x3b64361f,0xbbd9323e,0xbc00,0x323e3bd9,0xb61fbb64,0x38723aa7
.long 0x3c00,0x323ebbd9,0xb61f3b64,0x3872baa7,0xbc00,0xb8723aa7,0x3b64b61f,0xbbd9b23e
.long 0x3c00,0x3aa7b872,0xbb64b61f,0x323e3bd9,0xbc00,0xbbd9323e,0x361f3b64,0x3aa7b872
.long 0x3c00,0x3bd9323e,0x361fbb64,0xbaa7b872,0xbc00,0xbaa7b872,0xbb64361f,0xb23e3bd9
.long 0x3c00,0x38723aa7,0x3b64361f,0x3bd9b23e,0xbc00,0xb23ebbd9,0xb61fbb64,0xb872baa7
.long 0xb9a839a8,0xbaa73872,0xbb64361f,0xbbd9323e,0x39a839a8,0x323e3bd9,0xb61f3b64,0xbaa73872
.long 0x39a8b9a8,0x3bd9323e,0x361f3b64,0xb8723aa7,0xb9a8b9a8,0x3872baa7,0x3b64361f,0xb23e3bd9
.long 0xb9a839a8,0xb872baa7,0x3b64b61f,0x323e3bd9,0x39a839a8,0xbbd9323e,0x361fbb64,0x38723aa7
.long 0x39a8b9a8,0xb23e3bd9,0xb61fbb64,0x3aa73872,0xb9a8b9a8,0x3aa73872,0xbb64b61f,0x3bd9323e
.long 0xb9a839a8,0x3aa7b872,0xbb64361f,0x3bd9b23e,0x39a839a8,0xb23ebbd9,0xb61f3b64,0x3aa7b872
.long 0x39a8b9a8,0xbbd9b23e,0x361f3b64,0x3872baa7,0xb9a8b9a8,0xb8723aa7,0x3b64361f,0x323ebbd9
.long 0xb9a839a8,0x38723aa7,0x3b64b61f,0xb23ebbd9,0x39a839a8,0x3bd9b23e,0x361fbb64,0xb872baa7
.long 0x39a8b9a8,0x323ebbd9,0xb61fbb64,0xbaa7b872,0xb9a8b9a8,0xbaa7b872,0xbb64b61f,0xbbd9b23e
.long 0x3e800000,0x3e800000,0x3e800000,0x3e800000,0x3e800000,0x3e7ffb11,0x3e7fec43,0x3e7fd397
.long 0x3e800000,0x3e7fec43,0x3e7fb10f,0x3e7f4e6d,0x3e800000,0x3e7fd397,0x3e7f4e6d,0x3e7e70b0
.long 0x3e800000,0x3e7fb10f,0x3e7ec46d,0x3e7d3aac,0x3e800000,0x3e7f84ab,0x3e7e1324,0x3e7baccd
.long 0x3e800000,0x3e7f4e6d,0x3e7d3aac,0x3e79c79d,0x3e800000,0x3e7f0e58,0x3e7c3b28,0x3e778bc5
.long 0x3e800000,0x3e7ec46d,0x3e7b14be,0x3e74fa0b,0x3e800000,0x3e7e70b0,0x3e79c79d,0x3e721352
.long 0x3e800000,0x3e7e1324,0x3e7853f8,0x3e6ed89e,0x3e800000,0x3e7dabcc,0x3e76ba07,0x3e6b4b0c
.long 0x3e800000,0x3e7d3aac,0x3e74fa0b,0x3e676bd8,0x3e800000,0x3e7cbfc9,0x3e731447,0x3e633c5a
.long 0x3e800000,0x3e7c3b28,0x3e710908,0x3e5ebe05,0x3e800000,0x3e7baccd,0x3e6ed89e,0x3e59f26a
.long 0x3e800000,0x3e800000,0x3e800000,0x3e800000,0x3e7fb10f,0x3e7f84ab,0x3e7f4e6d,0x3e7f0e58
.long 0x3e7ec46d,0x3e7e1324,0x3e7d3aac,0x3e7c3b28,0x3e7d3aac,0x3e7baccd,0x3e79c79d,0x3e778bc5
.long 0x3e7b14be,0x3e7853f8,0x3e74fa0b,0x3e710908,0x3e7853f8,0x3e740bdd,0x3e6ed89e,0x3e68bf3c
.long 0x3e74fa0b,0x3e6ed89e,0x3e676bd8,0x3e5ebe05,0x3e710908,0x3e68bf3c,0x3e5ebe05,0x3e531849
.long 0x3e6c835e,0x3e61c598,0x3e54db31,0x3e45e403,0x3e676bd8,0x3e59f26a,0x3e49d112,0x3e373a23
.long 0x3e61c598,0x3e514d3d,0x3e3daef9,0x3e273656,0x3e5b941a,0x3e47de65,0x3e3085bb,0x3e15f6d9
.long 0x3e54db31,0x3e3daef9,0x3e226799,0x3e039c3d,0x3e4d9f02,0x3e32c8c9,0x3e13682a,0x3de0924f
.long 0x3e45e403,0x3e273656,0x3e039c3d,0x3db8442a,0x3e3daef9,0x3e1b02c6,0x3de63375,0x3d8e9a22
.long 0x3e800000,0x3e800000,0x3e800000,0x3e800000,0x3e7ec46d,0x3e7e70b0,0x3e7e1324,0x3e7dabcc
.long 0x3e7b14be,0x3e79c79d,0x3e7853f8,0x3e76ba07,0x3e74fa0b,0x3e721352,0x3e6ed89e,0x3e6b4b0c
.long 0x3e6c835e,0x3e676bd8,0x3e61c598,0x3e5b941a,0x3e61c598,0x3e59f26a,0x3e514d3d,0x3e47de65
.long 0x3e54db31,0x3e49d112,0x3e3daef9,0x3e3085bb,0x3e45e403,0x3e373a23,0x3e273656,0x3e15f6d9
.long 0x3e3504f3,0x3e226799,0x3e0e39da,0x3df15aea,0x3e226799,0x3e0b9a6b,0x3de63375,0x3db263ef
.long 0x3e0e39da,0x3de63375,0x3dac7cd4,0x3d605c13,0x3df15aea,0x3db263ef,0x3d605c13,0x3cafb680
.long 0x3dc3ef15,0x3d78cfcc,0x3cc8bd36,0xbc48fb30,0x3d94a031,0x3d09cf86,0xbbc90ab0,0xbd3b6ecf
.long 0x3d47c5c2,0x3bc90ab0,0xbd164083,0xbda09ae5,0x3cc8bd36,0xbcafb680,0xbd888e93,0xbde0924f
.long 0x3e800000,0x3e800000,0x3e800000,0x3e800000,0x3e7d3aac,0x3e7cbfc9,0x3e7c3b28,0x3e7baccd
.long 0x3e74fa0b,0x3e731447,0x3e710908,0x3e6ed89e,0x3e676bd8,0x3e633c5a,0x3e5ebe05,0x3e59f26a
.long 0x3e54db31,0x3e4d9f02,0x3e45e403,0x3e3daef9,0x3e3daef9,0x3e32c8c9,0x3e273656,0x3e1b02c6
.long 0x3e226799,0x3e13682a,0x3e039c3d,0x3de63375,0x3e039c3d,0x3de0924f,0x3db8442a,0x3d8e9a22
.long 0x3dc3ef15,0x3d94a031,0x3d47c5c2,0x3cc8bd36,0x3d78cfcc,0x3d09cf86,0x3bc90ab0,0xbcafb680
.long 0x3cc8bd36,0xbbc90ab0,0xbd164083,0xbd888e93,0xbc48fb30,0xbd3b6ecf,0xbda09ae5,0xbde0924f
.long 0xbd47c5c2,0xbdac7cd4,0xbdf15aea,0xbe187fc0,0xbdac7cd4,0xbdf6e0cb,0xbe1d7fd1,0xbe3b8f3b
.long 0xbdf15aea,0xbe1d7fd1,0xbe3daef9,0xbe584853,0xbe187fc0,0xbe3b8f3b,0xbe584853,0xbe6db293
.long 0x0,0x0,0x0,0x0,0x0,0x3b490e90,0x3bc90ab0,0x3c16c32c
.long 0x0,0x3bc90ab0,0x3c48fb30,0x3c96a905,0x0,0x3c16c32c,0x3c96a905,0x3ce1bc2e
.long 0x0,0x3c48fb30,0x3cc8bd36,0x3d164083,0x0,0x3c7b2b74,0x3cfab273,0x3d3b6ecf
.long 0x0,0x3c96a905,0x3d164083,0x3d605c13,0x0,0x3cafb680,0x3d2f10a2,0x3d827dc0
.long 0x0,0x3cc8bd36,0x3d47c5c2,0x3d94a031,0x0,0x3ce1bc2e,0x3d605c13,0x3da68f12
.long 0x0,0x3cfab273,0x3d78cfcc,0x3db8442a,0x0,0x3d09cf86,0x3d888e93,0x3dc9b953
.long 0x0,0x3d164083,0x3d94a031,0x3ddae880,0x0,0x3d22abb6,0x3da09ae5,0x3debcbbb
.long 0x0,0x3d2f10a2,0x3dac7cd4,0x3dfc5d27,0x0,0x3d3b6ecf,0x3db8442a,0x3e064b82
.long 0x0,0x0,0x0,0x0,0x3c48fb30,0x3c7b2b74,0x3c96a905,0x3cafb680
.long 0x3cc8bd36,0x3cfab273,0x3d164083,0x3d2f10a2,0x3d164083,0x3d3b6ecf,0x3d605c13,0x3d827dc0
.long 0x3d47c5c2,0x3d78cfcc,0x3d94a031,0x3dac7cd4,0x3d78cfcc,0x3d9aa086,0x3db8442a,0x3dd53641
.long 0x3d94a031,0x3db8442a,0x3ddae880,0x3dfc5d27,0x3dac7cd4,0x3dd53641,0x3dfc5d27,0x3e10d3cd
.long 0x3dc3ef15,0x3df15aea,0x3e0e39da,0x3e226799,0x3ddae880,0x3e064b82,0x3e1d7fd1,0x3e32c8c9
.long 0x3df15aea,0x3e13682a,0x3e2beb4a,0x3e41d870,0x3e039c3d,0x3e1ff6cb,0x3e396842,0x3e4f7a1f
.long 0x3e0e39da,0x3e2beb4a,0x3e45e403,0x3e5b941a,0x3e187fc0,0x3e373a23,0x3e514d3d,0x3e660f88
.long 0x3e226799,0x3e41d870,0x3e5b941a,0x3e6ed89e,0x3e2beb4a,0x3e4bbbf8,0x3e64aa59,0x3e75dec6
.long 0x0,0x0,0x0,0x0,0x3cc8bd36,0x3ce1bc2e,0x3cfab273,0x3d09cf86
.long 0x3d47c5c2,0x3d605c13,0x3d78cfcc,0x3d888e93,0x3d94a031,0x3da68f12,0x3db8442a,0x3dc9b953
.long 0x3dc3ef15,0x3ddae880,0x3df15aea,0x3e039c3d,0x3df15aea,0x3e064b82,0x3e13682a,0x3e1ff6cb
.long 0x3e0e39da,0x3e1d7fd1,0x3e2beb4a,0x3e396842,0x3e226799,0x3e32c8c9,0x3e41d870,0x3e4f7a1f
.long 0x3e3504f3,0x3e45e403,0x3e54db31,0x3e61c598,0x3e45e403,0x3e5695e5,0x3e64aa59,0x3e6ff573
.long 0x3e54db31,0x3e64aa59,0x3e710908,0x3e79c79d,0x3e61c598,0x3e6ff573,0x3e79c79d,0x3e7f0e58
.long 0x3e6c835e,0x3e7853f8,0x3e7ec46d,0x3e7fb10f,0x3e74fa0b,0x3e7dabcc,0x3e7fec43,0x3e7baccd
.long 0x3e7b14be,0x3e7fec43,0x3e7d3aac,0x3e731447,0x3e7ec46d,0x3e7f0e58,0x3e76ba07,0x3e660f88
.long 0x0,0x0,0x0,0x0,0x3d164083,0x3d22abb6,0x3d2f10a2,0x3d3b6ecf
.long 0x3d94a031,0x3da09ae5,0x3dac7cd4,0x3db8442a,0x3ddae880,0x3debcbbb,0x3dfc5d27,0x3e064b82
.long 0x3e0e39da,0x3e187fc0,0x3e226799,0x3e2beb4a,0x3e2beb4a,0x3e373a23,0x3e41d870,0x3e4bbbf8
.long 0x3e45e403,0x3e514d3d,0x3e5b941a,0x3e64aa59,0x3e5b941a,0x3e660f88,0x3e6ed89e,0x3e75dec6
.long 0x3e6c835e,0x3e74fa0b,0x3e7b14be,0x3e7ec46d,0x3e7853f8,0x3e7dabcc,0x3e7fec43,0x3e7f0e58
.long 0x3e7ec46d,0x3e7fec43,0x3e7d3aac,0x3e76ba07,0x3e7fb10f,0x3e7baccd,0x3e731447,0x3e660f88
.long 0x3e7b14be,0x3e710908,0x3e61c598,0x3e4d9f02,0x3e710908,0x3e604621,0x3e49d112,0x3e2e3bde
.long 0x3e61c598,0x3e49d112,0x3e2beb4a,0x3e08f59b,0x3e4d9f02,0x3e2e3bde,0x3e08f59b,0x3dbe1d4a
.long 0x3e800000,0x3e7ffec4,0x3e7ffb11,0x3e7ff4e6,0x3e800000,0x3e7ff4e6,0x3e7fd397,0x3e7f9c18
.long 0x3e800000,0x3e7fe129,0x3e7f84ab,0x3e7eea9d,0x3e800000,0x3e7fc38f,0x3e7f0e58,0x3e7de0b1
.long 0x3e800000,0x3e7f9c18,0x3e7e70b0,0x3e7c7eb0,0x3e800000,0x3e7f6ac7,0x3e7dabcc,0x3e7ac516
.long 0x3e800000,0x3e7f2f9d,0x3e7cbfc9,0x3e78b47b,0x3e800000,0x3e7eea9d,0x3e7baccd,0x3e764d97
.long 0x3e800000,0x3e7e9bc9,0x3e7a7302,0x3e73913f,0x3e800000,0x3e7e4323,0x3e791298,0x3e708066
.long 0x3e800000,0x3e7de0b1,0x3e778bc5,0x3e6d1c1d,0x3e800000,0x3e7d7474,0x3e75dec6,0x3e696591
.long 0x3e800000,0x3e7cfe73,0x3e740bdd,0x3e655e0b,0x3e800000,0x3e7c7eb0,0x3e721352,0x3e6106f2
.long 0x3e800000,0x3e7bf531,0x3e6ff573,0x3e5c61c7,0x3e800000,0x3e7b61fc,0x3e6db293,0x3e577026
.long 0x3e7fec43,0x3e7fe129,0x3e7fd397,0x3e7fc38f,0x3e7f4e6d,0x3e7eea9d,0x3e7e70b0,0x3e7de0b1
.long 0x3e7e1324,0x3e7cfe73,0x3e7baccd,0x3e7a1e84,0x3e7c3b28,0x3e7a1e84,0x3e778bc5,0x3e748422
.long 0x3e79c79d,0x3e764d97,0x3e721352,0x3e6d1c1d,0x3e76ba07,0x3e718f57,0x3e6b4b0c,0x3e63f473
.long 0x3e731447,0x3e6be858,0x3e633c5a,0x3e591e6a,0x3e6ed89e,0x3e655e0b,0x3e59f26a,0x3e4cae79
.long 0x3e6a09a7,0x3e5df6be,0x3e4f7a1f,0x3e3ebc1b,0x3e64aa59,0x3e55b993,0x3e43e200,0x3e2f61a5
.long 0x3e5ebe05,0x3e4cae79,0x3e373a23,0x3e1ebc12,0x3e584853,0x3e42de29,0x3e299415,0x3e0cead0
.long 0x3e514d3d,0x3e385216,0x3e1b02c6,0x3df41f07,0x3e49d112,0x3e2d1469,0x3e0b9a6b,0x3dcc9b8b
.long 0x3e41d870,0x3e212ff9,0x3df6e0cb,0x3da395c5,0x3e396842,0x3e14b039,0x3dd53641,0x3d72b651
.long 0x3e7fb10f,0x3e7f9c18,0x3e7f84ab,0x3e7f6ac7,0x3e7d3aac,0x3e7c7eb0,0x3e7baccd,0x3e7ac516
.long 0x3e7853f8,0x3e764d97,0x3e740bdd,0x3e718f57,0x3e710908,0x3e6d1c1d,0x3e68bf3c,0x3e63f473
.long 0x3e676bd8,0x3e6106f2,0x3e59f26a,0x3e5233c6,0x3e5b941a,0x3e5233c6,0x3e47de65,0x3e3ca003
.long 0x3e4d9f02,0x3e40d0da,0x3e32c8c9,0x3e239da9,0x3e3daef9,0x3e2d1469,0x3e1b02c6,0x3e07a136
.long 0x3e2beb4a,0x3e173c07,0x3e00e7e4,0x3dd25a09,0x3e187fc0,0x3dff17b2,0x3dc9b953,0x3d919ddd
.long 0x3e039c3d,0x3dcc9b8b,0x3d8e9a22,0x3d1c76de,0x3ddae880,0x3d97a117,0x3d22abb6,0x3b96c9b6
.long 0x3dac7cd4,0x3d419b37,0x3c16c32c,0xbcee3876,0x3d78cfcc,0x3ca3308c,0xbcafb680,0xbd7ee6e1
.long 0x3d164083,0xbbfb49ba,0xbd541501,0xbdc1071e,0x3c48fb30,0xbd1008b7,0xbda68f12,0xbdff17b2
.long 0x3e7f4e6d,0x3e7f2f9d,0x3e7f0e58,0x3e7eea9d,0x3e79c79d,0x3e78b47b,0x3e778bc5,0x3e764d97
.long 0x3e6ed89e,0x3e6be858,0x3e68bf3c,0x3e655e0b,0x3e5ebe05,0x3e591e6a,0x3e531849,0x3e4cae79
.long 0x3e49d112,0x3e40d0da,0x3e373a23,0x3e2d1469,0x3e3085bb,0x3e239da9,0x3e15f6d9,0x3e07a136
.long 0x3e13682a,0x3e0242b1,0x3de0924f,0x3dbb31a0,0x3de63375,0x3dbb31a0,0x3d8e9a22,0x3d419b37
.long 0x3da09ae5,0x3d5a3997,0x3ce1bc2e,0x3ac90f88,0x3d2f10a2,0x3c621469,0xbc7b2b74,0xbd354098
.long 0x3bc90ab0,0xbcd53db9,0xbd6c9a7f,0xbdb554ec,0xbcfab273,0xbd8586ce,0xbdc9b953,0xbe04f484
.long 0xbd888e93,0xbdd25a09,0xbe0b9a6b,0xbe2ac082,0xbdcf7bca,0xbe0cead0,0xbe2e3bde,0xbe4ac77f
.long 0xbe08f59b,0xbe2d1469,0xbe4bbbf8,0xbe63f473,0xbe273656,0xbe48d8b3,0xbe633c5a,0xbe756d97
.long 0x0,0x3ac90f88,0x3b490e90,0x3b96c9b6,0x0,0x3b96c9b6,0x3c16c32c,0x3c621469
.long 0x0,0x3bfb49ba,0x3c7b2b74,0x3cbc3ac3,0x0,0x3c2fe007,0x3cafb680,0x3d039502
.long 0x0,0x3c621469,0x3ce1bc2e,0x3d28defc,0x0,0x3c8a200a,0x3d09cf86,0x3d4dee60
.long 0x0,0x3ca3308c,0x3d22abb6,0x3d72b651,0x0,0x3cbc3ac3,0x3d3b6ecf,0x3d8b9507
.long 0x0,0x3cd53db9,0x3d541501,0x3d9d9e78,0x0,0x3cee3876,0x3d6c9a7f,0x3daf713a
.long 0x0,0x3d039502,0x3d827dc0,0x3dc1071e,0x0,0x3d1008b7,0x3d8e9a22,0x3dd25a09
.long 0x0,0x3d1c76de,0x3d9aa086,0x3de363fa,0x0,0x3d28defc,0x3da68f12,0x3df41f07
.long 0x0,0x3d354098,0x3db263ef,0x3e0242b1,0x0,0x3d419b37,0x3dbe1d4a,0x3e0a48ad
.long 0x3bc90ab0,0x3bfb49ba,0x3c16c32c,0x3c2fe007,0x3c96a905,0x3cbc3ac3,0x3ce1bc2e,0x3d039502
.long 0x3cfab273,0x3d1c76de,0x3d3b6ecf,0x3d5a3997,0x3d2f10a2,0x3d5a3997,0x3d827dc0,0x3d97a117
.long 0x3d605c13,0x3d8b9507,0x3da68f12,0x3dc1071e,0x3d888e93,0x3da986c4,0x3dc9b953,0x3de900b7
.long 0x3da09ae5,0x3dc6d529,0x3debcbbb,0x3e07a136,0x3db8442a,0x3de363fa,0x3e064b82,0x3e19c200
.long 0x3dcf7bca,0x3dff17b2,0x3e15f6d9,0x3e2ac082,0x3de63375,0x3e0cead0,0x3e24d225,0x3e3a7ca4
.long 0x3dfc5d27,0x3e19c200,0x3e32c8c9,0x3e48d8b3,0x3e08f59b,0x3e26050a,0x3e3fc767,0x3e55b993
.long 0x3e13682a,0x3e31a81d,0x3e4bbbf8,0x3e6106f2,0x3e1d7fd1,0x3e3ca003,0x3e5695e5,0x3e6aab7b
.long 0x3e273656,0x3e46e22a,0x3e604621,0x3e7294f8,0x3e3085bb,0x3e5064af,0x3e68bf3c,0x3e78b47b
.long 0x3c48fb30,0x3c621469,0x3c7b2b74,0x3c8a200a,0x3d164083,0x3d28defc,0x3d3b6ecf,0x3d4dee60
.long 0x3d78cfcc,0x3d8b9507,0x3d9aa086,0x3da986c4,0x3dac7cd4,0x3dc1071e,0x3dd53641,0x3de900b7
.long 0x3ddae880,0x3df41f07,0x3e064b82,0x3e121eb0,0x3e039c3d,0x3e121eb0,0x3e1ff6cb,0x3e2d1469
.long 0x3e187fc0,0x3e286605,0x3e373a23,0x3e44e3f5,0x3e2beb4a,0x3e3ca003,0x3e4bbbf8,0x3e591e6a
.long 0x3e3daef9,0x3e4e8d90,0x3e5d2d53,0x3e696591,0x3e4d9f02,0x3e5df6be,0x3e6b4b0c,0x3e756d97
.long 0x3e5b941a,0x3e6aab7b,0x3e75dec6,0x3e7cfe73,0x3e676bd8,0x3e748422,0x3e7cbfc9,0x3e7ff4e6
.long 0x3e710908,0x3e7b61fc,0x3e7fd397,0x3e7e4323,0x3e7853f8,0x3e7f2f9d,0x3e7f0e58,0x3e77f110
.long 0x3e7d3aac,0x3e7fe129,0x3e7a7302,0x3e6d1c1d,0x3e7fb10f,0x3e7d7474,0x3e721352,0x3e5df6be
.long 0x3c96a905,0x3ca3308c,0x3cafb680,0x3cbc3ac3,0x3d605c13,0x3d72b651,0x3d827dc0,0x3d8b9507
.long 0x3db8442a,0x3dc6d529,0x3dd53641,0x3de363fa,0x3dfc5d27,0x3e07a136,0x3e10d3cd,0x3e19c200
.long 0x3e1d7fd1,0x3e286605,0x3e32c8c9,0x3e3ca003,0x3e396842,0x3e44e3f5,0x3e4f7a1f,0x3e591e6a
.long 0x3e514d3d,0x3e5c61c7,0x3e660f88,0x3e6e46be,0x3e64aa59,0x3e6e46be,0x3e75dec6,0x3e7b61fc
.long 0x3e731447,0x3e7a1e84,0x3e7e70b0,0x3e7ffec4,0x3e7c3b28,0x3e7f9c18,0x3e7f84ab,0x3e7bf531
.long 0x3e7fec43,0x3e7e9bc9,0x3e791298,0x3e6f6830,0x3e7e1324,0x3e772417,0x3e6b4b0c,0x3e5ac450
.long 0x3e76ba07,0x3e696591,0x3e5695e5,0x3e3ebc1b,0x3e6a09a7,0x3e55b993,0x3e3b8f3b,0x3e1c420c
.long 0x3e584853,0x3e3ca003,0x3e1b02c6,0x3de900b7,0x3e41d870,0x3e1ebc12,0x3debcbbb,0x3d919ddd
.long 0x3e800000,0x3e800000,0x3e800000,0x3e800000,0x3e7b14be,0x3e7a7302,0x3e79c79d,0x3e791298
.long 0x3e6c835e,0x3e6a09a7,0x3e676bd8,0x3e64aa59,0x3e54db31,0x3e4f7a1f,0x3e49d112,0x3e43e200
.long 0x3e3504f3,0x3e2beb4a,0x3e226799,0x3e187fc0,0x3e0e39da,0x3e00e7e4,0x3de63375,0x3dc9b953
.long 0x3dc3ef15,0x3da09ae5,0x3d78cfcc,0x3d2f10a2,0x3d47c5c2,0x3ce1bc2e,0x3bc90ab0,0xbc7b2b74
.long 0x0,0xbcc8bd36,0xbd47c5c2,0xbd94a031,0xbd47c5c2,0xbd9aa086,0xbdcf7bca,0xbe00e7e4
.long 0xbdc3ef15,0xbdfc5d27,0xbe187fc0,0xbe3085bb,0xbe0e39da,0xbe299415,0xbe41d870,0xbe5695e5
.long 0xbe3504f3,0xbe4d9f02,0xbe61c598,0xbe710908,0xbe54db31,0xbe68bf3c,0xbe76ba07,0xbe7e70b0
.long 0xbe6c835e,0xbe79c79d,0xbe7fb10f,0xbe7e1324,0xbe7b14be,0xbe7ffb11,0xbe7c3b28,0xbe6ff573
.long 0x3e800000,0x3e800000,0x3e800000,0x3e800000,0x3e7853f8,0x3e778bc5,0x3e76ba07,0x3e75dec6
.long 0x3e61c598,0x3e5ebe05,0x3e5b941a,0x3e584853,0x3e3daef9,0x3e373a23,0x3e3085bb,0x3e299415
.long 0x3e0e39da,0x3e039c3d,0x3df15aea,0x3ddae880,0x3dac7cd4,0x3d8e9a22,0x3d605c13,0x3d22abb6
.long 0x3cc8bd36,0x3bc90ab0,0xbc48fb30,0xbcfab273,0xbd164083,0xbd6c9a7f,0xbda09ae5,0xbdc9b953
.long 0xbdc3ef15,0xbdf15aea,0xbe0e39da,0xbe226799,0xbe187fc0,0xbe2e3bde,0xbe41d870,0xbe531849
.long 0xbe45e403,0xbe584853,0xbe676bd8,0xbe731447,0xbe676bd8,0xbe740bdd,0xbe7c3b28,0xbe7fd397
.long 0xbe7b14be,0xbe7fb10f,0xbe7ec46d,0xbe7853f8,0xbe7fb10f,0xbe7a7302,0xbe6ed89e,0xbe5d2d53
.long 0xbe74fa0b,0xbe64aa59,0xbe4d9f02,0xbe3085bb,0xbe5b941a,0xbe3fc767,0xbe1d7fd1,0xbdebcbbb
.long 0x3e800000,0x3e800000,0x3e800000,0x3e800000,0x3e74fa0b,0x3e740bdd,0x3e731447,0x3e721352
.long 0x3e54db31,0x3e514d3d,0x3e4d9f02,0x3e49d112,0x3e226799,0x3e1b02c6,0x3e13682a,0x3e0b9a6b
.long 0x3dc3ef15,0x3dac7cd4,0x3d94a031,0x3d78cfcc,0x3cc8bd36,0x3c16c32c,0xbbc90ab0,0xbcafb680
.long 0xbd47c5c2,0xbd888e93,0xbdac7cd4,0xbdcf7bca,0xbdf15aea,0xbe0b9a6b,0xbe1d7fd1,0xbe2e3bde
.long 0xbe3504f3,0xbe45e403,0xbe54db31,0xbe61c598,0xbe61c598,0xbe6db293,0xbe76ba07,0xbe7cbfc9
.long 0xbe7b14be,0xbe7f4e6d,0xbe7fb10f,0xbe7c3b28,0xbe7ec46d,0xbe791298,0xbe6ed89e,0xbe604621
.long 0xbe6c835e,0xbe5b941a,0xbe45e403,0xbe2beb4a,0xbe45e403,0xbe299415,0xbe08f59b,0xbdc9b953
.long 0xbe0e39da,0xbdcf7bca,0xbd78cfcc,0xbc96a905,0xbd94a031,0xbce1bc2e,0x3c96a905,0x3d827dc0
.long 0x3e800000,0x3e800000,0x3e800000,0x3e800000,0x3e710908,0x3e6ff573,0x3e6ed89e,0x3e6db293
.long 0x3e45e403,0x3e41d870,0x3e3daef9,0x3e396842,0x3e039c3d,0x3df6e0cb,0x3de63375,0x3dd53641
.long 0x3d47c5c2,0x3d164083,0x3cc8bd36,0x3c48fb30,0xbd164083,0xbd541501,0xbd888e93,0xbda68f12
.long 0xbdf15aea,0xbe08f59b,0xbe187fc0,0xbe273656,0xbe3daef9,0xbe4bbbf8,0xbe584853,0xbe633c5a
.long 0xbe6c835e,0xbe74fa0b,0xbe7b14be,0xbe7ec46d,0xbe7fb10f,0xbe7f84ab,0xbe7c3b28,0xbe75dec6
.long 0xbe74fa0b,0xbe6a09a7,0xbe5b941a,0xbe49d112,0xbe4d9f02,0xbe373a23,0xbe1d7fd1,0xbe00e7e4
.long 0xbe0e39da,0xbddae880,0xbd94a031,0xbd164083,0xbd78cfcc,0xbcafb680,0x3c96a905,0x3d6c9a7f
.long 0x3cc8bd36,0x3d888e93,0x3ddae880,0x3e13682a,0x3ddae880,0x3e15f6d9,0x3e396842,0x3e5695e5
.long 0x0,0x0,0x0,0x0,0x3d47c5c2,0x3d541501,0x3d605c13,0x3d6c9a7f
.long 0x3dc3ef15,0x3dcf7bca,0x3ddae880,0x3de63375,0x3e0e39da,0x3e15f6d9,0x3e1d7fd1,0x3e24d225
.long 0x3e3504f3,0x3e3daef9,0x3e45e403,0x3e4d9f02,0x3e54db31,0x3e5d2d53,0x3e64aa59,0x3e6b4b0c
.long 0x3e6c835e,0x3e731447,0x3e7853f8,0x3e7c3b28,0x3e7b14be,0x3e7e70b0,0x3e7fec43,0x3e7f84ab
.long 0x3e800000,0x3e7ec46d,0x3e7b14be,0x3e74fa0b,0x3e7b14be,0x3e740bdd,0x3e6a09a7,0x3e5d2d53
.long 0x3e6c835e,0x3e5ebe05,0x3e4d9f02,0x3e396842,0x3e54db31,0x3e3fc767,0x3e273656,0x3e0b9a6b
.long 0x3e3504f3,0x3e187fc0,0x3df15aea,0x3dac7cd4,0x3e0e39da,0x3dd53641,0x3d888e93,0x3ce1bc2e
.long 0x3dc3ef15,0x3d605c13,0x3c48fb30,0xbcfab273,0x3d47c5c2,0x3b490e90,0xbd2f10a2,0xbdb263ef
.long 0x0,0x0,0x0,0x0,0x3d78cfcc,0x3d827dc0,0x3d888e93,0x3d8e9a22
.long 0x3df15aea,0x3dfc5d27,0x3e039c3d,0x3e08f59b,0x3e2beb4a,0x3e32c8c9,0x3e396842,0x3e3fc767
.long 0x3e54db31,0x3e5b941a,0x3e61c598,0x3e676bd8,0x3e710908,0x3e75dec6,0x3e79c79d,0x3e7cbfc9
.long 0x3e7ec46d,0x3e7fec43,0x3e7fb10f,0x3e7e1324,0x3e7d3aac,0x3e791298,0x3e731447,0x3e6b4b0c
.long 0x3e6c835e,0x3e61c598,0x3e54db31,0x3e45e403,0x3e4d9f02,0x3e3b8f3b,0x3e273656,0x3e10d3cd
.long 0x3e226799,0x3e08f59b,0x3ddae880,0x3da09ae5,0x3ddae880,0x3d9aa086,0x3d2f10a2,0x3c16c32c
.long 0x3d47c5c2,0x3c48fb30,0xbcc8bd36,0xbd78cfcc,0xbc48fb30,0xbd541501,0xbdb8442a,0xbe00e7e4
.long 0xbd94a031,0xbde63375,0xbe187fc0,0xbe396842,0xbe039c3d,0xbe299415,0xbe49d112,0xbe633c5a
.long 0x0,0x0,0x0,0x0,0x3d94a031,0x3d9aa086,0x3da09ae5,0x3da68f12
.long 0x3e0e39da,0x3e13682a,0x3e187fc0,0x3e1d7fd1,0x3e45e403,0x3e4bbbf8,0x3e514d3d,0x3e5695e5
.long 0x3e6c835e,0x3e710908,0x3e74fa0b,0x3e7853f8,0x3e7ec46d,0x3e7fd397,0x3e7fec43,0x3e7f0e58
.long 0x3e7b14be,0x3e76ba07,0x3e710908,0x3e6a09a7,0x3e61c598,0x3e5695e5,0x3e49d112,0x3e3b8f3b
.long 0x3e3504f3,0x3e226799,0x3e0e39da,0x3df15aea,0x3df15aea,0x3dbe1d4a,0x3d888e93,0x3d22abb6
.long 0x3d47c5c2,0x3c96a905,0xbc48fb30,0xbd2f10a2,0xbcc8bd36,0xbd6c9a7f,0xbdb8442a,0xbdf6e0cb
.long 0xbdc3ef15,0xbe039c3d,0xbe226799,0xbe3daef9,0xbe226799,0xbe3fc767,0xbe584853,0xbe6b4b0c
.long 0xbe54db31,0xbe6a09a7,0xbe7853f8,0xbe7f4e6d,0xbe74fa0b,0xbe7e70b0,0xbe7f4e6d,0xbe778bc5
.long 0x0,0x0,0x0,0x0,0x3dac7cd4,0x3db263ef,0x3db8442a,0x3dbe1d4a
.long 0x3e226799,0x3e273656,0x3e2beb4a,0x3e3085bb,0x3e5b941a,0x3e604621,0x3e64aa59,0x3e68bf3c
.long 0x3e7b14be,0x3e7d3aac,0x3e7ec46d,0x3e7fb10f,0x3e7d3aac,0x3e7a7302,0x3e76ba07,0x3e721352
.long 0x3e61c598,0x3e584853,0x3e4d9f02,0x3e41d870,0x3e2beb4a,0x3e1b02c6,0x3e08f59b,0x3debcbbb
.long 0x3dc3ef15,0x3d94a031,0x3d47c5c2,0x3cc8bd36,0x3c48fb30,0xbc7b2b74,0xbd2f10a2,0xbd8e9a22
.long 0xbd94a031,0xbdcf7bca,0xbe039c3d,0xbe1d7fd1,0xbe187fc0,0xbe32c8c9,0xbe49d112,0xbe5d2d53
.long 0xbe54db31,0xbe676bd8,0xbe74fa0b,0xbe7d3aac,0xbe7853f8,0xbe7f0e58,0xbe7f4e6d,0xbe791298
.long 0xbe7ec46d,0xbe76ba07,0xbe676bd8,0xbe514d3d,0xbe676bd8,0xbe4f7a1f,0xbe3085bb,0xbe0b9a6b
.long 0x3e7ec46d,0x3e7e9bc9,0x3e7e70b0,0x3e7e4323,0x3e74fa0b,0x3e73913f,0x3e721352,0x3e708066
.long 0x3e61c598,0x3e5df6be,0x3e59f26a,0x3e55b993,0x3e45e403,0x3e3ebc1b,0x3e373a23,0x3e2f61a5
.long 0x3e226799,0x3e173c07,0x3e0b9a6b,0x3dff17b2,0x3df15aea,0x3dd25a09,0x3db263ef,0x3d919ddd
.long 0x3d94a031,0x3d5a3997,0x3d09cf86,0x3c621469,0x3cc8bd36,0x3ac90f88,0xbcafb680,0xbd354098
.long 0xbcc8bd36,0xbd4dee60,0xbd9aa086,0xbdcc9b8b,0xbd94a031,0xbdcc9b8b,0xbe00e7e4,0xbe19c200
.long 0xbdf15aea,0xbe14b039,0xbe2e3bde,0xbe44e3f5,0xbe226799,0xbe3ca003,0xbe531849,0xbe655e0b
.long 0xbe45e403,0xbe5c61c7,0xbe6db293,0xbe796e4e,0xbe61c598,0xbe7294f8,0xbe7cbfc9,0xbe7ffec4
.long 0xbe74fa0b,0xbe7e4323,0xbe7f84ab,0xbe78b47b,0xbe7ec46d,0xbe7eea9d,0xbe75dec6,0xbe63f473
.long 0x3e7e1324,0x3e7de0b1,0x3e7dabcc,0x3e7d7474,0x3e6ed89e,0x3e6d1c1d,0x3e6b4b0c,0x3e696591
.long 0x3e514d3d,0x3e4cae79,0x3e47de65,0x3e42de29,0x3e273656,0x3e1ebc12,0x3e15f6d9,0x3e0cead0
.long 0x3de63375,0x3dcc9b8b,0x3db263ef,0x3d97a117,0x3d605c13,0x3d1c76de,0x3cafb680,0x3b96c9b6
.long 0xbbc90ab0,0xbcd53db9,0xbd3b6ecf,0xbd8586ce,0xbd888e93,0xbdb554ec,0xbde0924f,0xbe04f484
.long 0xbdfc5d27,0xbe14b039,0xbe299415,0xbe3ca003,0xbe3085bb,0xbe44e3f5,0xbe5695e5,0xbe655e0b
.long 0xbe584853,0xbe6816a8,0xbe740bdd,0xbe7bf531,0xbe731447,0xbe7bf531,0xbe7fd397,0xbe7e9bc9
.long 0xbe7f4e6d,0xbe7f2f9d,0xbe791298,0xbe6d1c1d,0xbe7c3b28,0xbe718f57,0xbe604621,0xbe48d8b3
.long 0xbe6a09a7,0xbe53fac3,0xbe373a23,0xbe14b039,0xbe49d112,0xbe286605,0xbe00e7e4,0xbda986c4
.long 0x3e7d3aac,0x3e7cfe73,0x3e7cbfc9,0x3e7c7eb0,0x3e676bd8,0x3e655e0b,0x3e633c5a,0x3e6106f2
.long 0x3e3daef9,0x3e385216,0x3e32c8c9,0x3e2d1469,0x3e039c3d,0x3df41f07,0x3de0924f,0x3dcc9b8b
.long 0x3d78cfcc,0x3d419b37,0x3d09cf86,0x3ca3308c,0xbc48fb30,0xbcee3876,0xbd3b6ecf,0xbd7ee6e1
.long 0xbdac7cd4,0xbdd25a09,0xbdf6e0cb,0xbe0cead0,0xbe187fc0,0xbe2ac082,0xbe3b8f3b,0xbe4ac77f
.long 0xbe4d9f02,0xbe5c61c7,0xbe68bf3c,0xbe7294f8,0xbe710908,0xbe796e4e,0xbe7e70b0,0xbe7ffec4
.long 0xbe7fb10f,0xbe7f2f9d,0xbe7a7302,0xbe718f57,0xbe7853f8,0xbe6d1c1d,0xbe5d2d53,0xbe48d8b3
.long 0xbe5b941a,0xbe44e3f5,0xbe299415,0xbe0a48ad,0xbe2beb4a,0xbe0a48ad,0xbdc9b953,0xbd72b651
.long 0xbddae880,0xbd8586ce,0xbcafb680,0x3cbc3ac3,0xbd164083,0x3c2fe007,0x3d6c9a7f,0x3dd25a09
.long 0x3e7c3b28,0x3e7bf531,0x3e7baccd,0x3e7b61fc,0x3e5ebe05,0x3e5c61c7,0x3e59f26a,0x3e577026
.long 0x3e273656,0x3e212ff9,0x3e1b02c6,0x3e14b039,0x3db8442a,0x3da395c5,0x3d8e9a22,0x3d72b651
.long 0x3bc90ab0,0xbbfb49ba,0xbcafb680,0xbd1008b7,0xbda09ae5,0xbdc1071e,0xbde0924f,0xbdff17b2
.long 0xbe1d7fd1,0xbe2d1469,0xbe3b8f3b,0xbe48d8b3,0xbe584853,0xbe63f473,0xbe6db293,0xbe756d97
.long 0xbe79c79d,0xbe7e4323,0xbe7ffb11,0xbe7eea9d,0xbe7e1324,0xbe78b47b,0xbe6ff573,0xbe63f473
.long 0xbe64aa59,0xbe53fac3,0xbe3fc767,0xbe286605,0xbe3085bb,0xbe14b039,0xbdebcbbb,0xbda986c4
.long 0xbdcf7bca,0xbd8586ce,0xbce1bc2e,0x3c2fe007,0xbc96a905,0x3cbc3ac3,0x3d827dc0,0x3dd25a09
.long 0x3d888e93,0x3dddbe79,0x3e15f6d9,0x3e385216,0x3e13682a,0x3e385216,0x3e5695e5,0x3e6d1c1d
.long 0x3cc8bd36,0x3cd53db9,0x3ce1bc2e,0x3cee3876,0x3d94a031,0x3d9d9e78,0x3da68f12,0x3daf713a
.long 0x3df15aea,0x3dff17b2,0x3e064b82,0x3e0cead0,0x3e226799,0x3e2ac082,0x3e32c8c9,0x3e3a7ca4
.long 0x3e45e403,0x3e4e8d90,0x3e5695e5,0x3e5df6be,0x3e61c598,0x3e696591,0x3e6ff573,0x3e756d97
.long 0x3e74fa0b,0x3e7a1e84,0x3e7dabcc,0x3e7f9c18,0x3e7ec46d,0x3e7ffec4,0x3e7f0e58,0x3e7bf531
.long 0x3e7ec46d,0x3e7ac516,0x3e740bdd,0x3e6aab7b,0x3e74fa0b,0x3e6aab7b,0x3e5d2d53,0x3e4cae79
.long 0x3e61c598,0x3e5064af,0x3e3b8f3b,0x3e239da9,0x3e45e403,0x3e2d1469,0x3e10d3cd,0x3de363fa
.long 0x3e226799,0x3e0242b1,0x3dbe1d4a,0x3d667c66,0x3df15aea,0x3da395c5,0x3d22abb6,0xbac90f88
.long 0x3d94a031,0x3cee3876,0xbc7b2b74,0xbd72b651,0x3cc8bd36,0xbcbc3ac3,0xbd8e9a22,0xbde900b7
.long 0x3cfab273,0x3d039502,0x3d09cf86,0x3d1008b7,0x3db8442a,0x3dc1071e,0x3dc9b953,0x3dd25a09
.long 0x3e13682a,0x3e19c200,0x3e1ff6cb,0x3e26050a,0x3e41d870,0x3e48d8b3,0x3e4f7a1f,0x3e55b993
.long 0x3e64aa59,0x3e6aab7b,0x3e6ff573,0x3e748422,0x3e79c79d,0x3e7cfe73,0x3e7f0e58,0x3e7ff4e6
.long 0x3e7fec43,0x3e7e9bc9,0x3e7baccd,0x3e772417,0x3e76ba07,0x3e6f6830,0x3e660f88,0x3e5ac450
.long 0x3e5ebe05,0x3e5064af,0x3e3fc767,0x3e2d1469,0x3e396842,0x3e239da9,0x3e0b9a6b,0x3de363fa
.long 0x3e08f59b,0x3dd8106b,0x3d9aa086,0x3d354098,0x3da09ae5,0x3d354098,0x3c16c32c,0xbcd53db9
.long 0x3c96a905,0xbca3308c,0xbd6c9a7f,0xbdc1071e,0xbd2f10a2,0xbda986c4,0xbdf6e0cb,0xbe1ebc12
.long 0xbdcf7bca,0xbe0f8784,0xbe32c8c9,0xbe5064af,0xbe1d7fd1,0xbe40d0da,0xbe5d2d53,0xbe718f57
.long 0x3d164083,0x3d1c76de,0x3d22abb6,0x3d28defc,0x3ddae880,0x3de363fa,0x3debcbbb,0x3df41f07
.long 0x3e2beb4a,0x3e31a81d,0x3e373a23,0x3e3ca003,0x3e5b941a,0x3e6106f2,0x3e660f88,0x3e6aab7b
.long 0x3e7853f8,0x3e7b61fc,0x3e7dabcc,0x3e7f2f9d,0x3e7fb10f,0x3e7e4323,0x3e7baccd,0x3e77f110
.long 0x3e710908,0x3e696591,0x3e604621,0x3e55b993,0x3e4d9f02,0x3e3ebc1b,0x3e2e3bde,0x3e1c420c
.long 0x3e187fc0,0x3e0242b1,0x3dd53641,0x3da395c5,0x3dac7cd4,0x3d667c66,0x3ce1bc2e,0xbac90f88
.long 0x3c48fb30,0xbca3308c,0xbd541501,0xbda986c4,0xbd78cfcc,0xbdc1071e,0xbe00e7e4,0xbe1ebc12
.long 0xbe039c3d,0xbe239da9,0xbe3fc767,0xbe577026,0xbe3daef9,0xbe577026,0xbe6b4b0c,0xbe78b47b
.long 0xbe676bd8,0xbe772417,0xbe7f0e58,0xbe7eea9d,0xbe7d3aac,0xbe7fc38f,0xbe791298,0xbe696591
.long 0x3d2f10a2,0x3d354098,0x3d3b6ecf,0x3d419b37,0x3dfc5d27,0x3e0242b1,0x3e064b82,0x3e0a48ad
.long 0x3e41d870,0x3e46e22a,0x3e4bbbf8,0x3e5064af,0x3e6ed89e,0x3e7294f8,0x3e75dec6,0x3e78b47b
.long 0x3e7fec43,0x3e7fe129,0x3e7f0e58,0x3e7d7474,0x3e731447,0x3e6d1c1d,0x3e660f88,0x3e5df6be
.long 0x3e49d112,0x3e3ca003,0x3e2e3bde,0x3e1ebc12,0x3e08f59b,0x3de900b7,0x3dbe1d4a,0x3d919ddd
.long 0x3d605c13,0x3cee3876,0x3b490e90,0xbcbc3ac3,0xbcfab273,0xbd72b651,0xbdb263ef,0xbde900b7
.long 0xbde63375,0xbe0f8784,0xbe299415,0xbe40d0da,0xbe396842,0xbe5064af,0xbe633c5a,0xbe718f57
.long 0xbe6a09a7,0xbe772417,0xbe7e70b0,0xbe7fc38f,0xbe7f4e6d,0xbe7eea9d,0xbe778bc5,0xbe696591
.long 0xbe76ba07,0xbe66becc,0xbe4f7a1f,0xbe31a81d,0xbe514d3d,0xbe31a81d,0xbe0b9a6b,0xbdc1071e
.long 0x80003c00,0x80003c00,0x80003c00,0x80003c00,0x80003c00,0xb9a839a8,0xbc000000,0xb9a8b9a8
.long 0x80003c00,0xbc000000,0x8000bc00,0x3c000000,0x80003c00,0xb9a8b9a8,0x3c000000,0xb9a839a8
.long 0x80003c00,0xb23e3bd9,0xb61f3b64,0xb8723aa7,0x80003c00,0xbaa73872,0xbb64b61f,0xb23ebbd9
.long 0x80003c00,0xbbd9b23e,0x361fbb64,0x3aa73872,0x80003c00,0xb872baa7,0x3b64361f,0xbbd9323e
.long 0x80003c00,0xb61f3b64,0xb9a839a8,0xbb64361f,0x80003c00,0xbb64361f,0xb9a8b9a8,0x361fbb64
.long 0x80003c00,0xbb64b61f,0x39a8b9a8,0x361f3b64,0x80003c00,0xb61fbb64,0x39a839a8,0xbb64b61f
.long 0x80003c00,0xb8723aa7,0xbb64361f,0xbbd9b23e,0x80003c00,0xbbd9323e,0xb61fbb64,0x3aa7b872
.long 0x80003c00,0xbaa7b872,0x3b64b61f,0xb23e3bd9,0x80003c00,0xb23ebbd9,0x361f3b64,0xb872baa7
.long 0x80003c00,0x80003c00,0x80003c00,0x80003c00,0x8000bc00,0x39a8b9a8,0x3c000000,0x39a839a8
.long 0x80003c00,0xbc000000,0x8000bc00,0x3c000000,0x8000bc00,0x39a839a8,0xbc000000,0x39a8b9a8
.long 0xb9a839a8,0xbaa73872,0xbb64361f,0xbbd9323e,0x39a8b9a8,0x3bd9323e,0x361f3b64,0xb8723aa7
.long 0xb9a839a8,0xb872baa7,0x3b64b61f,0x323e3bd9,0x39a8b9a8,0xb23e3bd9,0xb61fbb64,0x3aa73872
.long 0xbc000000,0xbb64b61f,0xb9a8b9a8,0xb61fbb64,0x3c000000,0x361f3b64,0xb9a839a8,0xbb64b61f
.long 0xbc000000,0x361fbb64,0x39a839a8,0xbb64361f,0x3c000000,0xbb64361f,0x39a8b9a8,0xb61f3b64
.long 0xb9a8b9a8,0xb23ebbd9,0x361fbb64,0x3aa7b872,0x39a839a8,0xb8723aa7,0xbb64b61f,0x323ebbd9
.long 0xb9a8b9a8,0x3bd9b23e,0xb61f3b64,0xb872baa7,0x39a839a8,0xbaa7b872,0x3b64361f,0xbbd9b23e
.long 0x80003c00,0x80003c00,0x80003c00,0x80003c00,0x80003c00,0xb9a839a8,0xbc000000,0xb9a8b9a8
.long 0x80003c00,0xbc000000,0x8000bc00,0x3c000000,0x80003c00,0xb9a8b9a8,0x3c000000,0xb9a839a8
.long 0xbc000000,0xbbd9b23e,0xbb64b61f,0xbaa7b872,0xbc000000,0xb872baa7,0x361fbb64,0x3bd9b23e
.long 0xbc000000,0x323ebbd9,0x3b64361f,0xb8723aa7,0xbc000000,0x3aa7b872,0xb61f3b64,0xb23ebbd9
.long 0x8000bc00,0x361fbb64,0x39a8b9a8,0x3b64b61f,0x8000bc00,0x3b64b61f,0x39a839a8,0xb61f3b64
.long 0x8000bc00,0x3b64361f,0xb9a839a8,0xb61fbb64,0x8000bc00,0x361f3b64,0xb9a8b9a8,0x3b64361f
.long 0x3c000000,0x3aa73872,0x361f3b64,0xb23e3bd9,0x3c000000,0x323e3bd9,0xbb64361f,0xb872baa7
.long 0x3c000000,0xb8723aa7,0xb61fbb64,0x3bd9323e,0x3c000000,0xbbd9323e,0x3b64b61f,0xbaa73872
.long 0x80003c00,0x80003c00,0x80003c00,0x80003c00,0x8000bc00,0x39a8b9a8,0x3c000000,0x39a839a8
.long 0x80003c00,0xbc000000,0x8000bc00,0x3c000000,0x8000bc00,0x39a839a8,0xbc000000,0x39a8b9a8
.long 0xb9a8b9a8,0xb872baa7,0xb61fbb64,0xb23ebbd9,0x39a839a8,0xb23e3bd9,0xbb64361f,0xbaa7b872
.long 0xb9a8b9a8,0x3aa7b872,0x361f3b64,0xbbd9323e,0x39a839a8,0xbbd9b23e,0x3b64b61f,0xb8723aa7
.long 0x3c000000,0x3b64361f,0x39a839a8,0x361f3b64,0xbc000000,0xb61fbb64,0x39a8b9a8,0x3b64361f
.long 0x3c000000,0xb61f3b64,0xb9a8b9a8,0x3b64b61f,0xbc000000,0x3b64b61f,0xb9a839a8,0x361fbb64
.long 0xb9a839a8,0xbbd9323e,0xbb64b61f,0xb872baa7,0x39a8b9a8,0x3aa73872,0xb61f3b64,0xbbd9b23e
.long 0xb9a839a8,0xb23ebbd9,0x3b64361f,0xbaa73872,0x39a8b9a8,0xb8723aa7,0x361fbb64,0xb23e3bd9
.long 0x80003c00,0x80003c00,0x80003c00,0x80003c00,0x80003c00,0xb9a839a8,0xbc000000,0xb9a8b9a8
.long 0x80003c00,0xbc000000,0x8000bc00,0x3c000000,0x80003c00,0xb9a8b9a8,0x3c000000,0xb9a839a8
.long 0x8000bc00,0x323ebbd9,0x361fbb64,0x3872baa7,0x8000bc00,0x3aa7b872,0x3b64361f,0x323e3bd9
.long 0x8000bc00,0x3bd9323e,0xb61f3b64,0xbaa7b872,0x8000bc00,0x38723aa7,0xbb64b61f,0x3bd9b23e
.long 0x80003c00,0xb61f3b64,0xb9a839a8,0xbb64361f,0x80003c00,0xbb64361f,0xb9a8b9a8,0x361fbb64
.long 0x80003c00,0xbb64b61f,0x39a8b9a8,0x361f3b64,0x80003c00,0xb61fbb64,0x39a839a8,0xbb64b61f
.long 0x8000bc00,0x3872baa7,0x3b64b61f,0x3bd9323e,0x8000bc00,0x3bd9b23e,0x361f3b64,0xbaa73872
.long 0x8000bc00,0x3aa73872,0xbb64361f,0x323ebbd9,0x8000bc00,0x323e3bd9,0xb61fbb64,0x38723aa7
.long 0x80003c00,0x80003c00,0x80003c00,0x80003c00,0x8000bc00,0x39a8b9a8,0x3c000000,0x39a839a8
.long 0x80003c00,0xbc000000,0x8000bc00,0x3c000000,0x8000bc00,0x39a839a8,0xbc000000,0x39a8b9a8
.long 0x39a8b9a8,0x3aa7b872,0x3b64b61f,0x3bd9b23e,0xb9a839a8,0xbbd9b23e,0xb61fbb64,0x3872baa7
.long 0x39a8b9a8,0x38723aa7,0xbb64361f,0xb23ebbd9,0xb9a839a8,0x323ebbd9,0x361f3b64,0xbaa7b872
.long 0xbc000000,0xbb64b61f,0xb9a8b9a8,0xb61fbb64,0x3c000000,0x361f3b64,0xb9a839a8,0xbb64b61f
.long 0xbc000000,0x361fbb64,0x39a839a8,0xbb64361f,0x3c000000,0xbb64361f,0x39a8b9a8,0xb61f3b64
.long 0x39a839a8,0x323e3bd9,0xb61f3b64,0xbaa73872,0xb9a8b9a8,0x3872baa7,0x3b64361f,0xb23e3bd9
.long 0x39a839a8,0xbbd9323e,0x361fbb64,0x38723aa7,0xb9a8b9a8,0x3aa73872,0xbb64b61f,0x3bd9323e
.long 0x80003c00,0x80003c00,0x80003c00,0x80003c00,0x80003c00,0xb9a839a8,0xbc000000,0xb9a8b9a8
.long 0x80003c00,0xbc000000,0x8000bc00,0x3c000000,0x80003c00,0xb9a8b9a8,0x3c000000,0xb9a839a8
.long 0x3c000000,0x3bd9323e,0x3b64361f,0x3aa73872,0x3c000000,0x38723aa7,0xb61f3b64,0xbbd9323e
.long 0x3c000000,0xb23e3bd9,0xbb64b61f,0x3872baa7,0x3c000000,0xbaa73872,0x361fbb64,0x323e3bd9
.long 0x8000bc00,0x361fbb64,0x39a8b9a8,0x3b64b61f,0x8000bc00,0x3b64b61f,0x39a839a8,0xb61f3b64
.long 0x8000bc00,0x3b64361f,0xb9a839a8,0xb61fbb64,0x8000bc00,0x361f3b64,0xb9a8b9a8,0x3b64361f
.long 0xbc000000,0xbaa7b872,0xb61fbb64,0x323ebbd9,0xbc000000,0xb23ebbd9,0x3b64b61f,0x38723aa7
.long 0xbc000000,0x3872baa7,0x361f3b64,0xbbd9b23e,0xbc000000,0x3bd9b23e,0xbb64361f,0x3aa7b872
.long 0x80003c00,0x80003c00,0x80003c00,0x80003c00,0x8000bc00,0x39a8b9a8,0x3c000000,0x39a839a8
.long 0x80003c00,0xbc000000,0x8000bc00,0x3c000000,0x8000bc00,0x39a839a8,0xbc000000,0x39a8b9a8
.long 0x39a839a8,0x38723aa7,0x361f3b64,0x323e3bd9,0xb9a8b9a8,0x323ebbd9,0x3b64b61f,0x3aa73872
.long 0x39a839a8,0xbaa73872,0xb61fbb64,0x3bd9b23e,0xb9a8b9a8,0x3bd9323e,0xbb64361f,0x3872baa7
.long 0x3c000000,0x3b64361f,0x39a839a8,0x361f3b64,0xbc000000,0xb61fbb64,0x39a8b9a8,0x3b64361f
.long 0x3c000000,0xb61f3b64,0xb9a8b9a8,0x3b64b61f,0xbc000000,0x3b64b61f,0xb9a839a8,0x361fbb64
.long 0x39a8b9a8,0x3bd9b23e,0x3b64361f,0x38723aa7,0xb9a839a8,0xbaa7b872,0x361fbb64,0x3bd9323e
.long 0x39a8b9a8,0x323e3bd9,0xbb64b61f,0x3aa7b872,0xb9a839a8,0x3872baa7,0xb61f3b64,0x323ebbd9
.long 0x80003c00,0x8000bc00,0x80003c00,0x8000bc00,0x80003c00,0x39a8b9a8,0xbc000000,0x39a839a8
.long 0x80003c00,0x3c000000,0x8000bc00,0xbc000000,0x80003c00,0x39a839a8,0x3c000000,0x39a8b9a8
.long 0x80003c00,0x323ebbd9,0xb61f3b64,0x3872baa7,0x80003c00,0x3aa7b872,0xbb64b61f,0x323e3bd9
.long 0x80003c00,0x3bd9323e,0x361fbb64,0xbaa7b872,0x80003c00,0x38723aa7,0x3b64361f,0x3bd9b23e
.long 0x80003c00,0x361fbb64,0xb9a839a8,0x3b64b61f,0x80003c00,0x3b64b61f,0xb9a8b9a8,0xb61f3b64
.long 0x80003c00,0x3b64361f,0x39a8b9a8,0xb61fbb64,0x80003c00,0x361f3b64,0x39a839a8,0x3b64361f
.long 0x80003c00,0x3872baa7,0xbb64361f,0x3bd9323e,0x80003c00,0x3bd9b23e,0xb61fbb64,0xbaa73872
.long 0x80003c00,0x3aa73872,0x3b64b61f,0x323ebbd9,0x80003c00,0x323e3bd9,0x361f3b64,0x38723aa7
.long 0x80003c00,0x8000bc00,0x80003c00,0x8000bc00,0x8000bc00,0xb9a839a8,0x3c000000,0xb9a8b9a8
.long 0x80003c00,0x3c000000,0x8000bc00,0xbc000000,0x8000bc00,0xb9a8b9a8,0xbc000000,0xb9a839a8
.long 0xb9a839a8,0x3aa7b872,0xbb64361f,0x3bd9b23e,0x39a8b9a8,0xbbd9b23e,0x361f3b64,0x3872baa7
.long 0xb9a839a8,0x38723aa7,0x3b64b61f,0xb23ebbd9,0x39a8b9a8,0x323ebbd9,0xb61fbb64,0xbaa7b872
.long 0xbc000000,0x3b64361f,0xb9a8b9a8,0x361f3b64,0x3c000000,0xb61fbb64,0xb9a839a8,0x3b64361f
.long 0xbc000000,0xb61f3b64,0x39a839a8,0x3b64b61f,0x3c000000,0x3b64b61f,0x39a8b9a8,0x361fbb64
.long 0xb9a8b9a8,0x323e3bd9,0x361fbb64,0xbaa73872,0x39a839a8,0x3872baa7,0xbb64b61f,0xb23e3bd9
.long 0xb9a8b9a8,0xbbd9323e,0xb61f3b64,0x38723aa7,0x39a839a8,0x3aa73872,0x3b64361f,0x3bd9323e
.long 0x80003c00,0x8000bc00,0x80003c00,0x8000bc00,0x80003c00,0x39a8b9a8,0xbc000000,0x39a839a8
.long 0x80003c00,0x3c000000,0x8000bc00,0xbc000000,0x80003c00,0x39a839a8,0x3c000000,0x39a8b9a8
.long 0xbc000000,0x3bd9323e,0xbb64b61f,0x3aa73872,0xbc000000,0x38723aa7,0x361fbb64,0xbbd9323e
.long 0xbc000000,0xb23e3bd9,0x3b64361f,0x3872baa7,0xbc000000,0xbaa73872,0xb61f3b64,0x323e3bd9
.long 0x8000bc00,0xb61f3b64,0x39a8b9a8,0xbb64361f,0x8000bc00,0xbb64361f,0x39a839a8,0x361fbb64
.long 0x8000bc00,0xbb64b61f,0xb9a839a8,0x361f3b64,0x8000bc00,0xb61fbb64,0xb9a8b9a8,0xbb64b61f
.long 0x3c000000,0xbaa7b872,0x361f3b64,0x323ebbd9,0x3c000000,0xb23ebbd9,0xbb64361f,0x38723aa7
.long 0x3c000000,0x3872baa7,0xb61fbb64,0xbbd9b23e,0x3c000000,0x3bd9b23e,0x3b64b61f,0x3aa7b872
.long 0x80003c00,0x8000bc00,0x80003c00,0x8000bc00,0x8000bc00,0xb9a839a8,0x3c000000,0xb9a8b9a8
.long 0x80003c00,0x3c000000,0x8000bc00,0xbc000000,0x8000bc00,0xb9a8b9a8,0xbc000000,0xb9a839a8
.long 0xb9a8b9a8,0x38723aa7,0xb61fbb64,0x323e3bd9,0x39a839a8,0x323ebbd9,0xbb64361f,0x3aa73872
.long 0xb9a8b9a8,0xbaa73872,0x361f3b64,0x3bd9b23e,0x39a839a8,0x3bd9323e,0x3b64b61f,0x3872baa7
.long 0x3c000000,0xbb64b61f,0x39a839a8,0xb61fbb64,0xbc000000,0x361f3b64,0x39a8b9a8,0xbb64b61f
.long 0x3c000000,0x361fbb64,0xb9a8b9a8,0xbb64361f,0xbc000000,0xbb64361f,0xb9a839a8,0xb61f3b64
.long 0xb9a839a8,0x3bd9b23e,0xbb64b61f,0x38723aa7,0x39a8b9a8,0xbaa7b872,0xb61f3b64,0x3bd9323e
.long 0xb9a839a8,0x323e3bd9,0x3b64361f,0x3aa7b872,0x39a8b9a8,0x3872baa7,0x361fbb64,0x323ebbd9
.long 0x80003c00,0x8000bc00,0x80003c00,0x8000bc00,0x80003c00,0x39a8b9a8,0xbc000000,0x39a839a8
.long 0x80003c00,0x3c000000,0x8000bc00,0xbc000000,0x80003c00,0x39a839a8,0x3c000000,0x39a8b9a8
.long 0x8000bc00,0xb23e3bd9,0x361fbb64,0xb8723aa7,0x8000bc00,0xbaa73872,0x3b64361f,0xb23ebbd9
.long 0x8000bc00,0xbbd9b23e,0xb61f3b64,0x3aa73872,0x8000bc00,0xb872baa7,0xbb64b61f,0xbbd9323e
.long 0x80003c00,0x361fbb64,0xb9a839a8,0x3b64b61f,0x80003c00,0x3b64b61f,0xb9a8b9a8,0xb61f3b64
.long 0x80003c00,0x3b64361f,0x39a8b9a8,0xb61fbb64,0x80003c00,0x361f3b64,0x39a839a8,0x3b64361f
.long 0x8000bc00,0xb8723aa7,0x3b64b61f,0xbbd9b23e,0x8000bc00,0xbbd9323e,0x361f3b64,0x3aa7b872
.long 0x8000bc00,0xbaa7b872,0xbb64361f,0xb23e3bd9,0x8000bc00,0xb23ebbd9,0xb61fbb64,0xb872baa7
.long 0x80003c00,0x8000bc00,0x80003c00,0x8000bc00,0x8000bc00,0xb9a839a8,0x3c000000,0xb9a8b9a8
.long 0x80003c00,0x3c000000,0x8000bc00,0xbc000000,0x8000bc00,0xb9a8b9a8,0xbc000000,0xb9a839a8
.long 0x39a8b9a8,0xbaa73872,0x3b64b61f,0xbbd9323e,0xb9a839a8,0x3bd9323e,0xb61fbb64,0xb8723aa7
.long 0x39a8b9a8,0xb872baa7,0xbb64361f,0x323e3bd9,0xb9a839a8,0xb23e3bd9,0x361f3b64,0x3aa73872
.long 0xbc000000,0x3b64361f,0xb9a8b9a8,0x361f3b64,0x3c000000,0xb61fbb64,0xb9a839a8,0x3b64361f
.long 0xbc000000,0xb61f3b64,0x39a839a8,0x3b64b61f,0x3c000000,0x3b64b61f,0x39a8b9a8,0x361fbb64
.long 0x39a839a8,0xb23ebbd9,0xb61f3b64,0x3aa7b872,0xb9a8b9a8,0xb8723aa7,0x3b64361f,0x323ebbd9
.long 0x39a839a8,0x3bd9b23e,0x361fbb64,0xb872baa7,0xb9a8b9a8,0xbaa7b872,0xbb64b61f,0xbbd9b23e
.long 0x80003c00,0x8000bc00,0x80003c00,0x8000bc00,0x80003c00,0x39a8b9a8,0xbc000000,0x39a839a8
.long 0x80003c00,0x3c000000,0x8000bc00,0xbc000000,0x80003c00,0x39a839a8,0x3c000000,0x39a8b9a8
.long 0x3c000000,0xbbd9b23e,0x3b64361f,0xbaa7b872,0x3c000000,0xb872baa7,0xb61f3b64,0x3bd9b23e
.long 0x3c000000,0x323ebbd9,0xbb64b61f,0xb8723aa7,0x3c000000,0x3aa7b872,0x361fbb64,0xb23ebbd9
.long 0x8000bc00,0xb61f3b64,0x39a8b9a8,0xbb64361f,0x8000bc00,0xbb64361f,0x39a839a8,0x361fbb64
.long 0x8000bc00,0xbb64b61f,0xb9a839a8,0x361f3b64,0x8000bc00,0xb61fbb64,0xb9a8b9a8,0xbb64b61f
.long 0xbc000000,0x3aa73872,0xb61fbb64,0xb23e3bd9,0xbc000000,0x323e3bd9,0x3b64b61f,0xb872baa7
.long 0xbc000000,0xb8723aa7,0x361f3b64,0x3bd9323e,0xbc000000,0xbbd9323e,0xbb64361f,0xbaa73872
.long 0x80003c00,0x8000bc00,0x80003c00,0x8000bc00,0x8000bc00,0xb9a839a8,0x3c000000,0xb9a8b9a8
.long 0x80003c00,0x3c000000,0x8000bc00,0xbc000000,0x8000bc00,0xb9a8b9a8,0xbc000000,0xb9a839a8
.long 0x39a839a8,0xb872baa7,0x361f3b64,0xb23ebbd9,0xb9a8b9a8,0xb23e3bd9,0x3b64b61f,0xbaa7b872
.long 0x39a839a8,0x3aa7b872,0xb61fbb64,0xbbd9323e,0xb9a8b9a8,0xbbd9b23e,0xbb64361f,0xb8723aa7
.long 0x3c000000,0xbb64b61f,0x39a839a8,0xb61fbb64,0xbc000000,0x361f3b64,0x39a8b9a8,0xbb64b61f
.long 0x3c000000,0x361fbb64,0xb9a8b9a8,0xbb64361f,0xbc000000,0xbb64361f,0xb9a839a8,0xb61f3b64
.long 0x39a8b9a8,0xbbd9323e,0x3b64361f,0xb872baa7,0xb9a839a8,0x3aa73872,0x361fbb64,0xbbd9b23e
.long 0x39a8b9a8,0xb23ebbd9,0xbb64b61f,0xbaa73872,0xb9a839a8,0xb8723aa7,0xb61f3b64,0xb23e3bd9
.size tab3, 16384
```
